```python
import torch

def _softmax(x, axis=-1):
    return torch.softmax(x, dim=axis)
def _gelu(x):
    return torch.nn.functional.gelu(x, approximate="tanh")
def _silu(x):
    return torch.nn.functional.silu(x)
def _sigmoid(x):
    return torch.sigmoid(x)
def _layernorm(x, axis=-1, eps=1e-5):
    m = x.mean(dim=axis, keepdim=True)
    v = x.var(dim=axis, keepdim=True, unbiased=False)
    return (x - m) / torch.sqrt(v + eps)
def _scatter_add(tgt, idx, src, axis=0):
    return tgt.clone().index_add_(axis, idx, src)
def _segment_sum(src, seg, n):
    out = torch.zeros((n,) + src.shape[1:], dtype=src.dtype)
    return out.index_add_(0, seg, src)
def _pad(x, pw):
    flat = tuple(v for pair in reversed(pw) for v in pair)
    return torch.nn.functional.pad(x, flat)

kernel_name = 'parallel_sum__mha_block__glu_gated_bilinear__prompt'

def setup_inputs():

    _w = (lambda a: (lambda t: t.to(torch.bfloat16) if t.is_floating_point() else t)(torch.as_tensor(a)))
    def _A_setup():
        B, S, D, H = 1, 2048, 640, 32
        return {
            "x": _w((lambda *s: torch.randn(*s, dtype=torch.bfloat16) * 0.05)(B, S, D)),
            "wqkv": _w((lambda *s: torch.randn(*s, dtype=torch.bfloat16) * 0.05)(D, 3 * D)),
            "wo": _w((lambda *s: torch.randn(*s, dtype=torch.bfloat16) * 0.05)(D, D)),
        }
    _A_in = _A_setup()

    def _B_setup():
        B, S, D, F = 1, 2048, 640, 1536
        return {
            "x": _w((lambda *s: torch.randn(*s, dtype=torch.bfloat16) * 0.05)(B, S, D)),
            "w_gate": _w((lambda *s: torch.randn(*s, dtype=torch.bfloat16) * 0.8)(D, F) * (D ** -0.5)),
            "w_up": _w((lambda *s: torch.randn(*s, dtype=torch.bfloat16) * 0.8)(D, F) * (D ** -0.5)),
            "w_down": _w((lambda *s: torch.randn(*s, dtype=torch.bfloat16) * 0.8)(F, D) * (F ** -0.5)),
        }
    _B_in = _B_setup()

    return {
        "A_x": _A_in["x"],
        "A_wqkv": _A_in["wqkv"],
        "A_wo": _A_in["wo"],
        "B_x": _B_in["x"],
        "B_w_gate": _B_in["w_gate"],
        "B_w_up": _B_in["w_up"],
        "B_w_down": _B_in["w_down"],
    }

def reference(A_x, A_wqkv, A_wo, B_x, B_w_gate, B_w_up, B_w_down):
    def _A_ref(x, wqkv, wo):
        B, S, D = x.shape
        H = 32
        Dh = D // H
        qkv = (lambda x, *d: x.permute(*d))((x @ wqkv).reshape(B, S, 3, H, Dh), 2, 0, 3, 1, 4)
        q, k, v = qkv[0], qkv[1], qkv[2]
        scores = torch.einsum("bhqd,bhkd->bhqk", q, k) * (Dh ** -0.5)
        p = _softmax(scores, axis=-1)
        o = torch.einsum("bhqk,bhkd->bhqd", p, v)
        return (lambda x, *d: x.permute(*d))(o, 0, 2, 1, 3).reshape(B, S, D) @ wo

    def _B_ref(x, w_gate, w_up, w_down):
        g = torch.einsum("bsd,df->bsf", x, w_gate)
        u = torch.einsum("bsd,df->bsf", x, w_up)
        h = g * u
        return torch.einsum("bsf,fd->bsd", h, w_down)

    x = A_x
    xn = _layernorm(x, axis=-1)
    return x + _A_ref(xn, A_wqkv, A_wo) + _B_ref(xn, B_w_gate, B_w_up, B_w_down)
```

```asm
; @launch grid=(256,1,1) block=(512,1,1) lds=163840
.amdgcn_target "amdgcn-amd-amdhsa--gfx950"
.text
.globl parallel_sum__mha_block__glu_gated_bilinear__prompt_kernel
.p2align 8
.type parallel_sum__mha_block__glu_gated_bilinear__prompt_kernel,@function
parallel_sum__mha_block__glu_gated_bilinear__prompt_kernel:
  s_cmp_ge_u32 s2, 256
  s_cbranch_scc1 L2_end
  s_load_dwordx4 s[4:7], s[0:1], 0
  s_load_dwordx4 s[8:11], s[0:1], 32
  s_load_dwordx4 s[92:95], s[0:1], 64
  s_load_dwordx2 s[96:97], s[0:1], 16
  s_load_dwordx4 s[76:79], s[0:1], 48
  v_lshrrev_b32 v3, 6, v0
  v_and_b32 v1, 63, v0
  v_readfirstlane_b32 s3, v3
  v_lshlrev_b32 v2, 4, v1
  s_and_b32 s38, s2, 1
  s_lshl_b32 s38, s38, 2
  s_bfe_u32 s39, s2, 0x20003
  s_add_u32 s29, s38, s39
  s_lshr_b32 s38, s2, 5
  s_bfe_u32 s39, s2, 0x20001
  s_lshl_b32 s36, s38, 2
  s_add_u32 s36, s36, s39
  s_mul_i32 s39, s39, 5
  s_add_u32 s39, s39, s38
  s_add_u32 s39, s39, 9
  s_cmp_lt_u32 s38, 3
  s_cselect_b32 s28, s36, s39
  s_and_b32 s30, s3, 3
  s_mov_b32 s20, 0xffff0000
  s_mov_b32 s91, 0
  v_cmp_gt_u32 vcc, 40, v1
  v_mov_b32 v3, 0x40000000
  s_nop 0
  v_cndmask_b32 v4, v3, v2, vcc
  s_mov_b64 s[86:87], vcc
  s_cmp_ge_u32 s3, 4
  s_cbranch_scc0 L1_consumer
L1_helper:
  v_lshrrev_b32 v66, 3, v1
  v_mul_u32_u24 v67, 1280, v66
  v_lshrrev_b32 v66, 4, v1
  v_and_b32 v68, 7, v1
  v_xor_b32 v68, v68, v66
  v_lshl_add_u32 v10, v68, 4, v67
  v_xor_b32 v68, 4, v68
  v_lshl_add_u32 v67, v68, 4, v67
  v_add_u32 v11, 10240, v67
  s_lshl_b32 s37, s29, 2
  s_add_u32 s37, s37, s30
  s_mul_i32 s44, s37, 81920
  s_add_u32 s45, s44, 20480
  s_add_u32 s46, s44, 40960
  s_add_u32 s47, s44, 61440
  s_lshl_b32 s19, s30, 13
  s_add_u32 s19, s19, 20736
  s_lshr_b32 s36, s30, 1
  v_add_u32 v66, 0, v1
  v_mul_u32_u24 v67, 6554, v66
  v_lshrrev_b32 v56, 16, v67
  v_mul_u32_u24 v67, 10, v56
  v_sub_u32 v67, v66, v67
  v_lshlrev_b32 v61, 4, v67
  v_add_u32 v66, 64, v1
  v_mul_u32_u24 v67, 6554, v66
  v_lshrrev_b32 v57, 16, v67
  v_mul_u32_u24 v67, 10, v57
  v_sub_u32 v67, v66, v67
  v_lshlrev_b32 v62, 4, v67
  v_add_u32 v66, 128, v1
  v_mul_u32_u24 v67, 6554, v66
  v_lshrrev_b32 v58, 16, v67
  v_mul_u32_u24 v67, 10, v58
  v_sub_u32 v67, v66, v67
  v_lshlrev_b32 v63, 4, v67
  v_add_u32 v66, 192, v1
  v_mul_u32_u24 v67, 6554, v66
  v_lshrrev_b32 v59, 16, v67
  v_mul_u32_u24 v67, 10, v59
  v_sub_u32 v67, v66, v67
  v_lshlrev_b32 v64, 4, v67
  v_add_u32 v66, 256, v1
  v_mul_u32_u24 v67, 6554, v66
  v_lshrrev_b32 v60, 16, v67
  v_mul_u32_u24 v67, 10, v60
  v_sub_u32 v67, v66, v67
  v_lshlrev_b32 v65, 4, v67
  s_waitcnt lgkmcnt(0)
  s_mov_b32 s52, s4
  s_mov_b32 s53, s5
  s_mov_b32 s54, 2621440
  s_mov_b32 s55, 0x00020000
  s_cmp_ge_u32 s28, 12
  s_cbranch_scc1 L1_setup_ffnH
  s_mul_i32 s37, s28, 320
  s_mul_i32 s38, s36, 160
  s_add_u32 s37, s37, s38
  s_add_u32 s12, s6, s37
  s_addc_u32 s13, s7, 0
  s_sub_u32 s14, 2457600, s37
  s_movk_i32 s16, 3840
  s_branch L1_setup_doneH
L1_setup_ffnH:
  s_sub_u32 s37, s28, 12
  s_mul_i32 s37, s37, 160
  s_cmp_eq_u32 s36, 0
  s_cselect_b32 s38, s8, s10
  s_cselect_b32 s39, s9, s11
  s_add_u32 s12, s38, s37
  s_addc_u32 s13, s39, 0
  s_sub_u32 s14, 1966080, s37
  s_movk_i32 s16, 3072
L1_setup_doneH:
  s_mov_b32 s15, 0x00020000
  s_lshl_b32 s17, s16, 6
  s_and_b32 s37, s30, 1
  s_lshl_b32 s38, s37, 5
  s_mul_i32 s18, s38, s16
  s_mul_i32 s34, s36, 10368
  s_mul_i32 s37, s37, 5120
  s_add_u32 s34, s34, s37
  v_mul_lo_u32 v66, v56, s16
  v_add_u32 v5, v66, v61
  v_mul_lo_u32 v66, v57, s16
  v_add_u32 v6, v66, v62
  v_mul_lo_u32 v66, v58, s16
  v_add_u32 v7, v66, v63
  v_mul_lo_u32 v66, v59, s16
  v_add_u32 v8, v66, v64
  v_mul_lo_u32 v66, v60, s16
  v_add_u32 v9, v66, v65
  s_mov_b32 s33, 0
  s_add_u32 s37, s33, s34
  s_add_u32 s38, s33, s19
  s_add_u32 m0, s37, 0
  s_nop 0
  buffer_load_dwordx4 v5, s[12:15], s18 offen lds
  s_add_u32 m0, s37, 1024
  s_nop 0
  buffer_load_dwordx4 v6, s[12:15], s18 offen lds
  s_add_u32 m0, s37, 2048
  s_nop 0
  buffer_load_dwordx4 v7, s[12:15], s18 offen lds
  s_add_u32 m0, s37, 3072
  s_nop 0
  buffer_load_dwordx4 v8, s[12:15], s18 offen lds
  s_add_u32 m0, s37, 4096
  s_nop 0
  buffer_load_dwordx4 v9, s[12:15], s18 offen lds
  s_add_u32 m0, s38, 0
  s_nop 0
  buffer_load_dwordx4 v10, s[52:55], s44 offen lds
  s_add_u32 m0, s38, 1024
  s_nop 0
  buffer_load_dwordx4 v11, s[52:55], s44 offen lds
  s_add_u32 m0, s38, 2048
  s_nop 0
  buffer_load_dwordx4 v10, s[52:55], s45 offen lds
  s_add_u32 m0, s38, 3072
  s_nop 0
  buffer_load_dwordx4 v11, s[52:55], s45 offen lds
  s_add_u32 m0, s38, 4096
  s_nop 0
  buffer_load_dwordx4 v10, s[52:55], s46 offen lds
  s_add_u32 m0, s38, 5120
  s_nop 0
  buffer_load_dwordx4 v11, s[52:55], s46 offen lds
  s_add_u32 m0, s38, 6144
  s_nop 0
  buffer_load_dwordx4 v10, s[52:55], s47 offen lds
  s_add_u32 m0, s38, 7168
  s_nop 0
  buffer_load_dwordx4 v11, s[52:55], s47 offen lds
  s_add_u32 s18, s18, s17
  s_add_u32 s44, s44, 128
  s_add_u32 s45, s45, 128
  s_add_u32 s46, s46, 128
  s_add_u32 s47, s47, 128
  s_add_u32 s33, s33, 53504
  s_cmp_eq_u32 s33, 160512
  s_cselect_b32 s33, 0, s33
  s_mov_b32 s24, s94
  s_mov_b32 s25, s95
  s_mov_b32 s26, 23756800
  s_mov_b32 s27, 0x00020000
  s_mov_b32 s60, s92
  s_mov_b32 s61, s93
  s_mov_b32 s62, 256
  s_mov_b32 s63, 0x00020000
  v_lshrrev_b32 v66, 3, v1
  v_min_u32 v66, 4, v66
  s_and_b32 s37, s30, 1
  s_mul_i32 s37, s37, 80
  s_mul_i32 s38, s36, 10368
  s_add_u32 s37, s37, s38
  v_and_b32 v67, 7, v1
  v_mul_u32_u24 v67, 160, v67
  v_lshl_add_u32 v67, v66, 4, v67
  v_add_u32 v12, s37, v67
  v_mov_b32 v16, 0
  v_mov_b32 v17, 0
  v_mov_b32 v18, 0
  v_mov_b32 v19, 0
  v_mov_b32 v20, 0
  v_mov_b32 v21, 0
  v_mov_b32 v22, 0
  v_mov_b32 v23, 0
  s_mov_b32 s35, 0
  s_mov_b32 s32, 0
  s_add_u32 s37, s33, s34
  s_add_u32 s38, s33, s19
  s_add_u32 m0, s37, 0
  s_nop 0
  buffer_load_dwordx4 v5, s[12:15], s18 offen lds
  s_add_u32 m0, s37, 1024
  s_nop 0
  buffer_load_dwordx4 v6, s[12:15], s18 offen lds
  s_add_u32 m0, s37, 2048
  s_nop 0
  buffer_load_dwordx4 v7, s[12:15], s18 offen lds
  s_add_u32 m0, s37, 3072
  s_nop 0
  buffer_load_dwordx4 v8, s[12:15], s18 offen lds
  s_add_u32 m0, s37, 4096
  s_nop 0
  buffer_load_dwordx4 v9, s[12:15], s18 offen lds
  s_add_u32 m0, s38, 0
  s_nop 0
  buffer_load_dwordx4 v10, s[52:55], s44 offen lds
  s_add_u32 m0, s38, 1024
  s_nop 0
  buffer_load_dwordx4 v11, s[52:55], s44 offen lds
  s_add_u32 m0, s38, 2048
  s_nop 0
  buffer_load_dwordx4 v10, s[52:55], s45 offen lds
  s_add_u32 m0, s38, 3072
  s_nop 0
  buffer_load_dwordx4 v11, s[52:55], s45 offen lds
  s_add_u32 m0, s38, 4096
  s_nop 0
  buffer_load_dwordx4 v10, s[52:55], s46 offen lds
  s_add_u32 m0, s38, 5120
  s_nop 0
  buffer_load_dwordx4 v11, s[52:55], s46 offen lds
  s_add_u32 m0, s38, 6144
  s_nop 0
  buffer_load_dwordx4 v10, s[52:55], s47 offen lds
  s_add_u32 m0, s38, 7168
  s_nop 0
  buffer_load_dwordx4 v11, s[52:55], s47 offen lds
  s_add_u32 s18, s18, s17
  s_add_u32 s44, s44, 128
  s_add_u32 s45, s45, 128
  s_add_u32 s46, s46, 128
  s_add_u32 s47, s47, 128
  s_add_u32 s33, s33, 53504
  s_cmp_eq_u32 s33, 160512
  s_cselect_b32 s33, 0, s33
  s_waitcnt vmcnt(13)
  s_barrier
  v_add_u32 v66, s32, v12
  ds_read_b128 v[24:27], v66 offset:0
  ds_read_b128 v[28:31], v66 offset:1280
  ds_read_b128 v[32:35], v66 offset:2560
  ds_read_b128 v[36:39], v66 offset:3840
  ds_read_b128 v[40:43], v66 offset:5120
  ds_read_b128 v[44:47], v66 offset:6400
  ds_read_b128 v[48:51], v66 offset:7680
  ds_read_b128 v[52:55], v66 offset:8960
  s_add_u32 s37, s33, s34
  s_add_u32 s38, s33, s19
  s_add_u32 m0, s37, 0
  s_nop 0
  buffer_load_dwordx4 v5, s[12:15], s18 offen lds
  s_waitcnt lgkmcnt(7)
  v_lshlrev_b32 v68, 16, v24
  v_and_b32 v69, s20, v24
  v_add_f32 v16, v16, v68
  v_add_f32 v17, v17, v69
  s_add_u32 m0, s37, 1024
  s_nop 0
  buffer_load_dwordx4 v6, s[12:15], s18 offen lds
  v_lshlrev_b32 v68, 16, v25
  v_and_b32 v69, s20, v25
  v_add_f32 v18, v18, v68
  v_add_f32 v19, v19, v69
  s_add_u32 m0, s37, 2048
  s_nop 0
  buffer_load_dwordx4 v7, s[12:15], s18 offen lds
  v_lshlrev_b32 v68, 16, v26
  v_and_b32 v69, s20, v26
  v_add_f32 v20, v20, v68
  v_add_f32 v21, v21, v69
  v_lshlrev_b32 v68, 16, v27
  v_and_b32 v69, s20, v27
  v_add_f32 v22, v22, v68
  v_add_f32 v23, v23, v69
  s_waitcnt lgkmcnt(6)
  v_lshlrev_b32 v68, 16, v28
  v_and_b32 v69, s20, v28
  v_add_f32 v16, v16, v68
  v_add_f32 v17, v17, v69
  s_add_u32 m0, s37, 3072
  s_nop 0
  buffer_load_dwordx4 v8, s[12:15], s18 offen lds
  v_lshlrev_b32 v68, 16, v29
  v_and_b32 v69, s20, v29
  v_add_f32 v18, v18, v68
  v_add_f32 v19, v19, v69
  v_lshlrev_b32 v68, 16, v30
  v_and_b32 v69, s20, v30
  v_add_f32 v20, v20, v68
  v_add_f32 v21, v21, v69
  v_lshlrev_b32 v68, 16, v31
  v_and_b32 v69, s20, v31
  v_add_f32 v22, v22, v68
  v_add_f32 v23, v23, v69
  s_add_u32 m0, s37, 4096
  s_nop 0
  buffer_load_dwordx4 v9, s[12:15], s18 offen lds
  s_waitcnt lgkmcnt(5)
  v_lshlrev_b32 v68, 16, v32
  v_and_b32 v69, s20, v32
  v_add_f32 v16, v16, v68
  v_add_f32 v17, v17, v69
  v_lshlrev_b32 v68, 16, v33
  v_and_b32 v69, s20, v33
  v_add_f32 v18, v18, v68
  v_add_f32 v19, v19, v69
  v_lshlrev_b32 v68, 16, v34
  v_and_b32 v69, s20, v34
  v_add_f32 v20, v20, v68
  v_add_f32 v21, v21, v69
  s_add_u32 m0, s38, 0
  s_nop 0
  buffer_load_dwordx4 v10, s[52:55], s44 offen lds
  v_lshlrev_b32 v68, 16, v35
  v_and_b32 v69, s20, v35
  v_add_f32 v22, v22, v68
  v_add_f32 v23, v23, v69
  s_waitcnt lgkmcnt(4)
  v_lshlrev_b32 v68, 16, v36
  v_and_b32 v69, s20, v36
  v_add_f32 v16, v16, v68
  v_add_f32 v17, v17, v69
  v_lshlrev_b32 v68, 16, v37
  v_and_b32 v69, s20, v37
  v_add_f32 v18, v18, v68
  v_add_f32 v19, v19, v69
  s_add_u32 m0, s38, 1024
  s_nop 0
  buffer_load_dwordx4 v11, s[52:55], s44 offen lds
  v_lshlrev_b32 v68, 16, v38
  v_and_b32 v69, s20, v38
  v_add_f32 v20, v20, v68
  v_add_f32 v21, v21, v69
  v_lshlrev_b32 v68, 16, v39
  v_and_b32 v69, s20, v39
  v_add_f32 v22, v22, v68
  v_add_f32 v23, v23, v69
  s_waitcnt lgkmcnt(3)
  v_lshlrev_b32 v68, 16, v40
  v_and_b32 v69, s20, v40
  v_add_f32 v16, v16, v68
  v_add_f32 v17, v17, v69
  s_add_u32 m0, s38, 2048
  s_nop 0
  buffer_load_dwordx4 v10, s[52:55], s45 offen lds
  v_lshlrev_b32 v68, 16, v41
  v_and_b32 v69, s20, v41
  v_add_f32 v18, v18, v68
  v_add_f32 v19, v19, v69
  v_lshlrev_b32 v68, 16, v42
  v_and_b32 v69, s20, v42
  v_add_f32 v20, v20, v68
  v_add_f32 v21, v21, v69
  v_lshlrev_b32 v68, 16, v43
  v_and_b32 v69, s20, v43
  v_add_f32 v22, v22, v68
  v_add_f32 v23, v23, v69
  s_add_u32 m0, s38, 3072
  s_nop 0
  buffer_load_dwordx4 v11, s[52:55], s45 offen lds
  s_waitcnt lgkmcnt(2)
  v_lshlrev_b32 v68, 16, v44
  v_and_b32 v69, s20, v44
  v_add_f32 v16, v16, v68
  v_add_f32 v17, v17, v69
  v_lshlrev_b32 v68, 16, v45
  v_and_b32 v69, s20, v45
  v_add_f32 v18, v18, v68
  v_add_f32 v19, v19, v69
  v_lshlrev_b32 v68, 16, v46
  v_and_b32 v69, s20, v46
  v_add_f32 v20, v20, v68
  v_add_f32 v21, v21, v69
  s_add_u32 m0, s38, 4096
  s_nop 0
  buffer_load_dwordx4 v10, s[52:55], s46 offen lds
  v_lshlrev_b32 v68, 16, v47
  v_and_b32 v69, s20, v47
  v_add_f32 v22, v22, v68
  v_add_f32 v23, v23, v69
  s_waitcnt lgkmcnt(1)
  v_lshlrev_b32 v68, 16, v48
  v_and_b32 v69, s20, v48
  v_add_f32 v16, v16, v68
  v_add_f32 v17, v17, v69
  v_lshlrev_b32 v68, 16, v49
  v_and_b32 v69, s20, v49
  v_add_f32 v18, v18, v68
  v_add_f32 v19, v19, v69
  s_add_u32 m0, s38, 5120
  s_nop 0
  buffer_load_dwordx4 v11, s[52:55], s46 offen lds
  v_lshlrev_b32 v68, 16, v50
  v_and_b32 v69, s20, v50
  v_add_f32 v20, v20, v68
  v_add_f32 v21, v21, v69
  v_lshlrev_b32 v68, 16, v51
  v_and_b32 v69, s20, v51
  v_add_f32 v22, v22, v68
  v_add_f32 v23, v23, v69
  s_waitcnt lgkmcnt(0)
  v_lshlrev_b32 v68, 16, v52
  v_and_b32 v69, s20, v52
  v_add_f32 v16, v16, v68
  v_add_f32 v17, v17, v69
  s_add_u32 m0, s38, 6144
  s_nop 0
  buffer_load_dwordx4 v10, s[52:55], s47 offen lds
  v_lshlrev_b32 v68, 16, v53
  v_and_b32 v69, s20, v53
  v_add_f32 v18, v18, v68
  v_add_f32 v19, v19, v69
  v_lshlrev_b32 v68, 16, v54
  v_and_b32 v69, s20, v54
  v_add_f32 v20, v20, v68
  v_add_f32 v21, v21, v69
  v_lshlrev_b32 v68, 16, v55
  v_and_b32 v69, s20, v55
  v_add_f32 v22, v22, v68
  v_add_f32 v23, v23, v69
  s_add_u32 m0, s38, 7168
  s_nop 0
  buffer_load_dwordx4 v11, s[52:55], s47 offen lds
  s_add_u32 s18, s18, s17
  s_add_u32 s44, s44, 128
  s_add_u32 s45, s45, 128
  s_add_u32 s46, s46, 128
  s_add_u32 s47, s47, 128
  s_add_u32 s33, s33, 53504
  s_cmp_eq_u32 s33, 160512
  s_cselect_b32 s33, 0, s33
  s_add_u32 s32, s32, 53504
  s_cmp_eq_u32 s32, 160512
  s_cselect_b32 s32, 0, s32
  s_waitcnt vmcnt(13)
  s_barrier
L1_hloop:
  v_add_u32 v66, s32, v12
  ds_read_b128 v[24:27], v66 offset:0
  ds_read_b128 v[28:31], v66 offset:1280
  ds_read_b128 v[32:35], v66 offset:2560
  ds_read_b128 v[36:39], v66 offset:3840
  ds_read_b128 v[40:43], v66 offset:5120
  ds_read_b128 v[44:47], v66 offset:6400
  ds_read_b128 v[48:51], v66 offset:7680
  ds_read_b128 v[52:55], v66 offset:8960
  s_add_u32 s37, s33, s34
  s_add_u32 s38, s33, s19
  s_add_u32 m0, s37, 0
  s_nop 0
  buffer_load_dwordx4 v5, s[12:15], s18 offen lds
  s_waitcnt lgkmcnt(7)
  v_lshlrev_b32 v68, 16, v24
  v_and_b32 v69, s20, v24
  v_add_f32 v16, v16, v68
  v_add_f32 v17, v17, v69
  s_add_u32 m0, s37, 1024
  s_nop 0
  buffer_load_dwordx4 v6, s[12:15], s18 offen lds
  v_lshlrev_b32 v68, 16, v25
  v_and_b32 v69, s20, v25
  v_add_f32 v18, v18, v68
  v_add_f32 v19, v19, v69
  s_add_u32 m0, s37, 2048
  s_nop 0
  buffer_load_dwordx4 v7, s[12:15], s18 offen lds
  v_lshlrev_b32 v68, 16, v26
  v_and_b32 v69, s20, v26
  v_add_f32 v20, v20, v68
  v_add_f32 v21, v21, v69
  v_lshlrev_b32 v68, 16, v27
  v_and_b32 v69, s20, v27
  v_add_f32 v22, v22, v68
  v_add_f32 v23, v23, v69
  s_waitcnt lgkmcnt(6)
  v_lshlrev_b32 v68, 16, v28
  v_and_b32 v69, s20, v28
  v_add_f32 v16, v16, v68
  v_add_f32 v17, v17, v69
  s_add_u32 m0, s37, 3072
  s_nop 0
  buffer_load_dwordx4 v8, s[12:15], s18 offen lds
  v_lshlrev_b32 v68, 16, v29
  v_and_b32 v69, s20, v29
  v_add_f32 v18, v18, v68
  v_add_f32 v19, v19, v69
  v_lshlrev_b32 v68, 16, v30
  v_and_b32 v69, s20, v30
  v_add_f32 v20, v20, v68
  v_add_f32 v21, v21, v69
  v_lshlrev_b32 v68, 16, v31
  v_and_b32 v69, s20, v31
  v_add_f32 v22, v22, v68
  v_add_f32 v23, v23, v69
  s_add_u32 m0, s37, 4096
  s_nop 0
  buffer_load_dwordx4 v9, s[12:15], s18 offen lds
  s_waitcnt lgkmcnt(5)
  v_lshlrev_b32 v68, 16, v32
  v_and_b32 v69, s20, v32
  v_add_f32 v16, v16, v68
  v_add_f32 v17, v17, v69
  v_lshlrev_b32 v68, 16, v33
  v_and_b32 v69, s20, v33
  v_add_f32 v18, v18, v68
  v_add_f32 v19, v19, v69
  v_lshlrev_b32 v68, 16, v34
  v_and_b32 v69, s20, v34
  v_add_f32 v20, v20, v68
  v_add_f32 v21, v21, v69
  s_add_u32 m0, s38, 0
  s_nop 0
  buffer_load_dwordx4 v10, s[52:55], s44 offen lds
  v_lshlrev_b32 v68, 16, v35
  v_and_b32 v69, s20, v35
  v_add_f32 v22, v22, v68
  v_add_f32 v23, v23, v69
  s_waitcnt lgkmcnt(4)
  v_lshlrev_b32 v68, 16, v36
  v_and_b32 v69, s20, v36
  v_add_f32 v16, v16, v68
  v_add_f32 v17, v17, v69
  v_lshlrev_b32 v68, 16, v37
  v_and_b32 v69, s20, v37
  v_add_f32 v18, v18, v68
  v_add_f32 v19, v19, v69
  s_add_u32 m0, s38, 1024
  s_nop 0
  buffer_load_dwordx4 v11, s[52:55], s44 offen lds
  v_lshlrev_b32 v68, 16, v38
  v_and_b32 v69, s20, v38
  v_add_f32 v20, v20, v68
  v_add_f32 v21, v21, v69
  v_lshlrev_b32 v68, 16, v39
  v_and_b32 v69, s20, v39
  v_add_f32 v22, v22, v68
  v_add_f32 v23, v23, v69
  s_waitcnt lgkmcnt(3)
  v_lshlrev_b32 v68, 16, v40
  v_and_b32 v69, s20, v40
  v_add_f32 v16, v16, v68
  v_add_f32 v17, v17, v69
  s_add_u32 m0, s38, 2048
  s_nop 0
  buffer_load_dwordx4 v10, s[52:55], s45 offen lds
  v_lshlrev_b32 v68, 16, v41
  v_and_b32 v69, s20, v41
  v_add_f32 v18, v18, v68
  v_add_f32 v19, v19, v69
  v_lshlrev_b32 v68, 16, v42
  v_and_b32 v69, s20, v42
  v_add_f32 v20, v20, v68
  v_add_f32 v21, v21, v69
  v_lshlrev_b32 v68, 16, v43
  v_and_b32 v69, s20, v43
  v_add_f32 v22, v22, v68
  v_add_f32 v23, v23, v69
  s_add_u32 m0, s38, 3072
  s_nop 0
  buffer_load_dwordx4 v11, s[52:55], s45 offen lds
  s_waitcnt lgkmcnt(2)
  v_lshlrev_b32 v68, 16, v44
  v_and_b32 v69, s20, v44
  v_add_f32 v16, v16, v68
  v_add_f32 v17, v17, v69
  v_lshlrev_b32 v68, 16, v45
  v_and_b32 v69, s20, v45
  v_add_f32 v18, v18, v68
  v_add_f32 v19, v19, v69
  v_lshlrev_b32 v68, 16, v46
  v_and_b32 v69, s20, v46
  v_add_f32 v20, v20, v68
  v_add_f32 v21, v21, v69
  s_add_u32 m0, s38, 4096
  s_nop 0
  buffer_load_dwordx4 v10, s[52:55], s46 offen lds
  v_lshlrev_b32 v68, 16, v47
  v_and_b32 v69, s20, v47
  v_add_f32 v22, v22, v68
  v_add_f32 v23, v23, v69
  s_waitcnt lgkmcnt(1)
  v_lshlrev_b32 v68, 16, v48
  v_and_b32 v69, s20, v48
  v_add_f32 v16, v16, v68
  v_add_f32 v17, v17, v69
  v_lshlrev_b32 v68, 16, v49
  v_and_b32 v69, s20, v49
  v_add_f32 v18, v18, v68
  v_add_f32 v19, v19, v69
  s_add_u32 m0, s38, 5120
  s_nop 0
  buffer_load_dwordx4 v11, s[52:55], s46 offen lds
  v_lshlrev_b32 v68, 16, v50
  v_and_b32 v69, s20, v50
  v_add_f32 v20, v20, v68
  v_add_f32 v21, v21, v69
  v_lshlrev_b32 v68, 16, v51
  v_and_b32 v69, s20, v51
  v_add_f32 v22, v22, v68
  v_add_f32 v23, v23, v69
  s_waitcnt lgkmcnt(0)
  v_lshlrev_b32 v68, 16, v52
  v_and_b32 v69, s20, v52
  v_add_f32 v16, v16, v68
  v_add_f32 v17, v17, v69
  s_add_u32 m0, s38, 6144
  s_nop 0
  buffer_load_dwordx4 v10, s[52:55], s47 offen lds
  v_lshlrev_b32 v68, 16, v53
  v_and_b32 v69, s20, v53
  v_add_f32 v18, v18, v68
  v_add_f32 v19, v19, v69
  v_lshlrev_b32 v68, 16, v54
  v_and_b32 v69, s20, v54
  v_add_f32 v20, v20, v68
  v_add_f32 v21, v21, v69
  v_lshlrev_b32 v68, 16, v55
  v_and_b32 v69, s20, v55
  v_add_f32 v22, v22, v68
  v_add_f32 v23, v23, v69
  s_add_u32 m0, s38, 7168
  s_nop 0
  buffer_load_dwordx4 v11, s[52:55], s47 offen lds
  s_add_u32 s18, s18, s17
  s_add_u32 s44, s44, 128
  s_add_u32 s45, s45, 128
  s_add_u32 s46, s46, 128
  s_add_u32 s47, s47, 128
  s_add_u32 s33, s33, 53504
  s_cmp_eq_u32 s33, 160512
  s_cselect_b32 s33, 0, s33
  s_add_u32 s32, s32, 53504
  s_cmp_eq_u32 s32, 160512
  s_cselect_b32 s32, 0, s32
  s_waitcnt vmcnt(13)
  s_barrier
  s_add_u32 s35, s35, 1
  s_cmp_lt_u32 s35, 7
  s_cbranch_scc1 L1_hloop
  s_lshl_b32 s36, s29, 5
  v_mov_b32 v75, 0
  s_movk_i32 s21, 400
  buffer_load_dword v76, v75, s[60:63], s36 offen sc1
  v_add_u32 v66, s32, v12
  ds_read_b128 v[24:27], v66 offset:0
  ds_read_b128 v[28:31], v66 offset:1280
  ds_read_b128 v[32:35], v66 offset:2560
  ds_read_b128 v[36:39], v66 offset:3840
  ds_read_b128 v[40:43], v66 offset:5120
  ds_read_b128 v[44:47], v66 offset:6400
  ds_read_b128 v[48:51], v66 offset:7680
  ds_read_b128 v[52:55], v66 offset:8960
  s_waitcnt lgkmcnt(7)
  v_lshlrev_b32 v68, 16, v24
  v_and_b32 v69, s20, v24
  v_add_f32 v16, v16, v68
  v_add_f32 v17, v17, v69
  v_lshlrev_b32 v68, 16, v25
  v_and_b32 v69, s20, v25
  v_add_f32 v18, v18, v68
  v_add_f32 v19, v19, v69
  v_lshlrev_b32 v68, 16, v26
  v_and_b32 v69, s20, v26
  v_add_f32 v20, v20, v68
  v_add_f32 v21, v21, v69
  v_lshlrev_b32 v68, 16, v27
  v_and_b32 v69, s20, v27
  v_add_f32 v22, v22, v68
  v_add_f32 v23, v23, v69
  s_waitcnt lgkmcnt(6)
  v_lshlrev_b32 v68, 16, v28
  v_and_b32 v69, s20, v28
  v_add_f32 v16, v16, v68
  v_add_f32 v17, v17, v69
  v_lshlrev_b32 v68, 16, v29
  v_and_b32 v69, s20, v29
  v_add_f32 v18, v18, v68
  v_add_f32 v19, v19, v69
  v_lshlrev_b32 v68, 16, v30
  v_and_b32 v69, s20, v30
  v_add_f32 v20, v20, v68
  v_add_f32 v21, v21, v69
  v_lshlrev_b32 v68, 16, v31
  v_and_b32 v69, s20, v31
  v_add_f32 v22, v22, v68
  v_add_f32 v23, v23, v69
  s_waitcnt lgkmcnt(5)
  v_lshlrev_b32 v68, 16, v32
  v_and_b32 v69, s20, v32
  v_add_f32 v16, v16, v68
  v_add_f32 v17, v17, v69
  v_lshlrev_b32 v68, 16, v33
  v_and_b32 v69, s20, v33
  v_add_f32 v18, v18, v68
  v_add_f32 v19, v19, v69
  v_lshlrev_b32 v68, 16, v34
  v_and_b32 v69, s20, v34
  v_add_f32 v20, v20, v68
  v_add_f32 v21, v21, v69
  v_lshlrev_b32 v68, 16, v35
  v_and_b32 v69, s20, v35
  v_add_f32 v22, v22, v68
  v_add_f32 v23, v23, v69
  s_waitcnt lgkmcnt(4)
  v_lshlrev_b32 v68, 16, v36
  v_and_b32 v69, s20, v36
  v_add_f32 v16, v16, v68
  v_add_f32 v17, v17, v69
  v_lshlrev_b32 v68, 16, v37
  v_and_b32 v69, s20, v37
  v_add_f32 v18, v18, v68
  v_add_f32 v19, v19, v69
  v_lshlrev_b32 v68, 16, v38
  v_and_b32 v69, s20, v38
  v_add_f32 v20, v20, v68
  v_add_f32 v21, v21, v69
  v_lshlrev_b32 v68, 16, v39
  v_and_b32 v69, s20, v39
  v_add_f32 v22, v22, v68
  v_add_f32 v23, v23, v69
  s_waitcnt lgkmcnt(3)
  v_lshlrev_b32 v68, 16, v40
  v_and_b32 v69, s20, v40
  v_add_f32 v16, v16, v68
  v_add_f32 v17, v17, v69
  v_lshlrev_b32 v68, 16, v41
  v_and_b32 v69, s20, v41
  v_add_f32 v18, v18, v68
  v_add_f32 v19, v19, v69
  v_lshlrev_b32 v68, 16, v42
  v_and_b32 v69, s20, v42
  v_add_f32 v20, v20, v68
  v_add_f32 v21, v21, v69
  v_lshlrev_b32 v68, 16, v43
  v_and_b32 v69, s20, v43
  v_add_f32 v22, v22, v68
  v_add_f32 v23, v23, v69
  s_waitcnt lgkmcnt(2)
  v_lshlrev_b32 v68, 16, v44
  v_and_b32 v69, s20, v44
  v_add_f32 v16, v16, v68
  v_add_f32 v17, v17, v69
  v_lshlrev_b32 v68, 16, v45
  v_and_b32 v69, s20, v45
  v_add_f32 v18, v18, v68
  v_add_f32 v19, v19, v69
  v_lshlrev_b32 v68, 16, v46
  v_and_b32 v69, s20, v46
  v_add_f32 v20, v20, v68
  v_add_f32 v21, v21, v69
  v_lshlrev_b32 v68, 16, v47
  v_and_b32 v69, s20, v47
  v_add_f32 v22, v22, v68
  v_add_f32 v23, v23, v69
  s_waitcnt lgkmcnt(1)
  v_lshlrev_b32 v68, 16, v48
  v_and_b32 v69, s20, v48
  v_add_f32 v16, v16, v68
  v_add_f32 v17, v17, v69
  v_lshlrev_b32 v68, 16, v49
  v_and_b32 v69, s20, v49
  v_add_f32 v18, v18, v68
  v_add_f32 v19, v19, v69
  v_lshlrev_b32 v68, 16, v50
  v_and_b32 v69, s20, v50
  v_add_f32 v20, v20, v68
  v_add_f32 v21, v21, v69
  v_lshlrev_b32 v68, 16, v51
  v_and_b32 v69, s20, v51
  v_add_f32 v22, v22, v68
  v_add_f32 v23, v23, v69
  s_waitcnt lgkmcnt(0)
  v_lshlrev_b32 v68, 16, v52
  v_and_b32 v69, s20, v52
  v_add_f32 v16, v16, v68
  v_add_f32 v17, v17, v69
  v_lshlrev_b32 v68, 16, v53
  v_and_b32 v69, s20, v53
  v_add_f32 v18, v18, v68
  v_add_f32 v19, v19, v69
  v_lshlrev_b32 v68, 16, v54
  v_and_b32 v69, s20, v54
  v_add_f32 v20, v20, v68
  v_add_f32 v21, v21, v69
  v_lshlrev_b32 v68, 16, v55
  v_and_b32 v69, s20, v55
  v_add_f32 v22, v22, v68
  v_add_f32 v23, v23, v69
  s_add_u32 s32, s32, 53504
  s_cmp_eq_u32 s32, 160512
  s_cselect_b32 s32, 0, s32
  s_branch L1_pchk
L1_poll:
  s_sleep 2
  buffer_load_dword v76, v75, s[60:63], s36 offen sc1
L1_pchk:
  s_waitcnt vmcnt(0)
  v_readfirstlane_b32 s37, v76
  s_nop 1
  s_cmp_ge_u32 s37, 32
  s_cbranch_scc1 L1_pok
  s_sub_u32 s21, s21, 1
  s_cmp_gt_i32 s21, 0
  s_cbranch_scc1 L1_poll
  s_lshl_b32 s51, s29, 8
  s_lshl_b32 s37, s30, 6
  s_add_u32 s51, s51, s37
  s_mov_b32 s35, 0
L1_fb:
  s_mul_i32 s37, s51, 1280
  buffer_load_dwordx4 v[80:83], v4, s[52:55], s37 offen
  buffer_load_dwordx4 v[84:87], v4, s[52:55], s37 offen offset:640
  s_waitcnt vmcnt(0)
  v_lshlrev_b32 v88, 16, v80
  v_and_b32 v89, s20, v80
  v_lshlrev_b32 v90, 16, v81
  v_and_b32 v91, s20, v81
  v_lshlrev_b32 v92, 16, v82
  v_and_b32 v93, s20, v82
  v_lshlrev_b32 v94, 16, v83
  v_and_b32 v95, s20, v83
  v_lshlrev_b32 v96, 16, v84
  v_and_b32 v97, s20, v84
  v_lshlrev_b32 v98, 16, v85
  v_and_b32 v99, s20, v85
  v_lshlrev_b32 v100, 16, v86
  v_and_b32 v101, s20, v86
  v_lshlrev_b32 v102, 16, v87
  v_and_b32 v103, s20, v87
  v_add_f32 v104, v88, v89
  v_add_f32 v105, v90, v91
  v_add_f32 v104, v104, v92
  v_add_f32 v105, v105, v93
  v_add_f32 v104, v104, v94
  v_add_f32 v105, v105, v95
  v_add_f32 v104, v104, v96
  v_add_f32 v105, v105, v97
  v_add_f32 v104, v104, v98
  v_add_f32 v105, v105, v99
  v_add_f32 v104, v104, v100
  v_add_f32 v105, v105, v101
  v_add_f32 v104, v104, v102
  v_add_f32 v105, v105, v103
  v_add_f32 v104, v104, v105
  s_nop 1
  v_add_f32_dpp v104, v104, v104 row_ror:8 row_mask:0xf bank_mask:0xf
  s_nop 1
  v_add_f32_dpp v104, v104, v104 row_ror:4 row_mask:0xf bank_mask:0xf
  s_nop 1
  v_add_f32_dpp v104, v104, v104 row_ror:2 row_mask:0xf bank_mask:0xf
  s_nop 1
  v_add_f32_dpp v104, v104, v104 row_ror:1 row_mask:0xf bank_mask:0xf
  v_mov_b32 v105, v104
  s_nop 1
  v_permlane16_swap_b32 v104, v105
  v_add_f32 v104, v104, v105
  v_mov_b32 v105, v104
  s_nop 1
  v_permlane32_swap_b32 v104, v105
  v_add_f32 v104, v104, v105
  v_mul_f32 v104, 0x3acccccd, v104
  v_mov_b32 v105, 0
  v_mov_b32 v106, 0
  s_mov_b64 exec, s[86:87]
  v_sub_f32 v107, v88, v104
  v_sub_f32 v108, v89, v104
  v_fmac_f32 v105, v107, v107
  v_fmac_f32 v106, v108, v108
  v_sub_f32 v107, v90, v104
  v_sub_f32 v108, v91, v104
  v_fmac_f32 v105, v107, v107
  v_fmac_f32 v106, v108, v108
  v_sub_f32 v107, v92, v104
  v_sub_f32 v108, v93, v104
  v_fmac_f32 v105, v107, v107
  v_fmac_f32 v106, v108, v108
  v_sub_f32 v107, v94, v104
  v_sub_f32 v108, v95, v104
  v_fmac_f32 v105, v107, v107
  v_fmac_f32 v106, v108, v108
  v_sub_f32 v107, v96, v104
  v_sub_f32 v108, v97, v104
  v_fmac_f32 v105, v107, v107
  v_fmac_f32 v106, v108, v108
  v_sub_f32 v107, v98, v104
  v_sub_f32 v108, v99, v104
  v_fmac_f32 v105, v107, v107
  v_fmac_f32 v106, v108, v108
  v_sub_f32 v107, v100, v104
  v_sub_f32 v108, v101, v104
  v_fmac_f32 v105, v107, v107
  v_fmac_f32 v106, v108, v108
  v_sub_f32 v107, v102, v104
  v_sub_f32 v108, v103, v104
  v_fmac_f32 v105, v107, v107
  v_fmac_f32 v106, v108, v108
  s_mov_b64 exec, -1
  v_add_f32 v105, v105, v106
  s_nop 1
  v_add_f32_dpp v105, v105, v105 row_ror:8 row_mask:0xf bank_mask:0xf
  s_nop 1
  v_add_f32_dpp v105, v105, v105 row_ror:4 row_mask:0xf bank_mask:0xf
  s_nop 1
  v_add_f32_dpp v105, v105, v105 row_ror:2 row_mask:0xf bank_mask:0xf
  s_nop 1
  v_add_f32_dpp v105, v105, v105 row_ror:1 row_mask:0xf bank_mask:0xf
  v_mov_b32 v106, v105
  s_nop 1
  v_permlane16_swap_b32 v105, v106
  v_add_f32 v105, v105, v106
  v_mov_b32 v106, v105
  s_nop 1
  v_permlane32_swap_b32 v105, v106
  v_add_f32 v105, v105, v106
  v_mul_f32 v105, 0x3acccccd, v105
  v_cvt_pk_bf16_f32 v106, v104, v105
  v_lshlrev_b32 v104, 16, v106
  v_and_b32 v105, s20, v106
  v_add_f32 v105, 0x3727c5ac, v105
  v_cvt_pk_bf16_f32 v105, v105, v105
  v_and_b32 v105, s20, v105
  v_sqrt_f32 v105, v105
  s_nop 0
  v_cvt_pk_bf16_f32 v105, v105, v105
  v_and_b32 v105, s20, v105
  v_rcp_f32 v105, v105
  v_cmp_eq_u32 vcc, 0, v1
  v_lshlrev_b32 v106, 13, v1
  s_lshl_b32 s37, s51, 2
  v_cndmask_b32 v104, v105, v104, vcc
  s_mov_b64 exec, 3
  buffer_store_dword v104, v106, s[24:27], s37 offen offset:0 sc1
  s_mov_b64 exec, -1
  s_add_u32 s51, s51, 1
  s_add_u32 s35, s35, 1
  s_cmp_lt_u32 s35, 64
  s_cbranch_scc1 L1_fb
  s_waitcnt vmcnt(0)
L1_pok:
  s_lshl_b32 s36, s29, 10
  s_lshl_b32 s37, s30, 8
  s_add_u32 s36, s36, s37
  s_add_u32 s38, s36, 8192
  v_lshlrev_b32 v72, 2, v1
  buffer_load_dword v73, v72, s[24:27], s36 offen offset:0 sc1
  buffer_load_dword v74, v72, s[24:27], s38 offen offset:0 sc1
  s_add_u32 s37, s37, 160512
  v_add_u32 v72, s37, v72
  v_bfe_u32 v77, v1, 1, 3
  v_lshlrev_b32 v77, 4, v77
  v_lshl_add_u32 v77, v1, 7, v77
  s_add_u32 s37, s33, s19
  v_add_u32 v77, s37, v77
  v_xor_b32 v78, 16, v77
  v_mov_b32 v80, 0
  v_mov_b32 v81, 0
  v_mov_b32 v82, 0
  v_mov_b32 v83, 0
  v_mov_b32 v84, 0
  v_mov_b32 v85, 0
  v_mov_b32 v86, 0
  v_mov_b32 v87, 0
  s_sub_u32 s84, s2, 96
  s_lshl_b32 s84, s84, 2
  s_add_u32 s84, s84, s30
  s_lshr_b32 s37, s84, 3
  s_and_b32 s38, s84, 7
  s_mul_i32 s39, s38, 160
  s_cmp_lt_u32 s37, 20
  s_cselect_b32 s56, s96, s76
  s_cselect_b32 s57, s97, s77
  s_mov_b32 s58, 1966080
  s_cselect_b32 s58, 819200, s58
  s_cselect_b32 s85, 0, 20
  s_mov_b32 s59, 0x00020000
  s_sub_u32 s85, s37, s85
  s_mul_i32 s85, s85, 40960
  s_add_u32 s85, s85, s39
  s_cmp_lt_u32 s84, 544
  s_cselect_b32 s85, s85, 0x40000000
  s_mul_i32 s88, s38, 348160
  s_mul_i32 s37, s37, 5120
  s_add_u32 s88, s88, s37
  s_add_u32 s88, s88, 20971520
  s_add_u32 s89, s88, 4096
  s_cmp_lt_u32 s84, 544
  s_cselect_b32 s91, 3, 0
  s_mul_i32 s39, s30, 5120
  s_add_u32 s39, s39, 107008
  s_cmp_lt_u32 s84, 544
  s_cselect_b32 s39, s39, 0x30000
  s_lshl_b32 s37, s30, 2
  s_add_u32 s37, s37, 161536
  v_mov_b32 v101, s37
  v_mov_b32 v102, 0
  ds_write_b32 v101, v102
  v_mul_u32_u24 v96, 1280, v56
  v_add_u32 v96, v96, v61
  v_mul_u32_u24 v97, 1280, v57
  v_add_u32 v97, v97, v62
  v_mul_u32_u24 v98, 1280, v58
  v_add_u32 v98, v98, v63
  v_mul_u32_u24 v99, 1280, v59
  v_add_u32 v99, v99, v64
  v_mul_u32_u24 v100, 1280, v60
  v_add_u32 v100, v100, v65
  s_barrier
  s_add_u32 m0, s39, 0
  s_nop 0
  buffer_load_dwordx4 v96, s[56:59], s85 offen lds
  s_add_u32 m0, s39, 1024
  s_nop 0
  buffer_load_dwordx4 v97, s[56:59], s85 offen lds
  s_add_u32 m0, s39, 2048
  s_nop 0
  buffer_load_dwordx4 v98, s[56:59], s85 offen lds
  s_add_u32 m0, s39, 3072
  s_nop 0
  buffer_load_dwordx4 v99, s[56:59], s85 offen lds
  s_add_u32 m0, s39, 4096
  s_nop 0
  buffer_load_dwordx4 v100, s[56:59], s85 offen lds
  ds_write_b128 v78, v[84:87]
  v_add_u32 v79, s33, v12
  ds_write_b128 v79, v[84:87] offset:1280
  v_add_u32 v66, s32, v12
  ds_read_b128 v[24:27], v66 offset:0
  ds_read_b128 v[28:31], v66 offset:1280
  ds_read_b128 v[32:35], v66 offset:2560
  ds_read_b128 v[36:39], v66 offset:3840
  ds_read_b128 v[40:43], v66 offset:5120
  ds_read_b128 v[44:47], v66 offset:6400
  ds_read_b128 v[48:51], v66 offset:7680
  ds_read_b128 v[52:55], v66 offset:8960
  s_waitcnt lgkmcnt(7)
  v_lshlrev_b32 v68, 16, v24
  v_and_b32 v69, s20, v24
  v_add_f32 v16, v16, v68
  v_add_f32 v17, v17, v69
  v_lshlrev_b32 v68, 16, v25
  v_and_b32 v69, s20, v25
  v_add_f32 v18, v18, v68
  v_add_f32 v19, v19, v69
  v_lshlrev_b32 v68, 16, v26
  v_and_b32 v69, s20, v26
  v_add_f32 v20, v20, v68
  v_add_f32 v21, v21, v69
  v_lshlrev_b32 v68, 16, v27
  v_and_b32 v69, s20, v27
  v_add_f32 v22, v22, v68
  v_add_f32 v23, v23, v69
  s_waitcnt lgkmcnt(6)
  v_lshlrev_b32 v68, 16, v28
  v_and_b32 v69, s20, v28
  v_add_f32 v16, v16, v68
  v_add_f32 v17, v17, v69
  v_lshlrev_b32 v68, 16, v29
  v_and_b32 v69, s20, v29
  v_add_f32 v18, v18, v68
  v_add_f32 v19, v19, v69
  v_lshlrev_b32 v68, 16, v30
  v_and_b32 v69, s20, v30
  v_add_f32 v20, v20, v68
  v_add_f32 v21, v21, v69
  v_lshlrev_b32 v68, 16, v31
  v_and_b32 v69, s20, v31
  v_add_f32 v22, v22, v68
  v_add_f32 v23, v23, v69
  s_waitcnt lgkmcnt(5)
  v_lshlrev_b32 v68, 16, v32
  v_and_b32 v69, s20, v32
  v_add_f32 v16, v16, v68
  v_add_f32 v17, v17, v69
  v_lshlrev_b32 v68, 16, v33
  v_and_b32 v69, s20, v33
  v_add_f32 v18, v18, v68
  v_add_f32 v19, v19, v69
  v_lshlrev_b32 v68, 16, v34
  v_and_b32 v69, s20, v34
  v_add_f32 v20, v20, v68
  v_add_f32 v21, v21, v69
  v_lshlrev_b32 v68, 16, v35
  v_and_b32 v69, s20, v35
  v_add_f32 v22, v22, v68
  v_add_f32 v23, v23, v69
  s_waitcnt lgkmcnt(4)
  v_lshlrev_b32 v68, 16, v36
  v_and_b32 v69, s20, v36
  v_add_f32 v16, v16, v68
  v_add_f32 v17, v17, v69
  v_lshlrev_b32 v68, 16, v37
  v_and_b32 v69, s20, v37
  v_add_f32 v18, v18, v68
  v_add_f32 v19, v19, v69
  v_lshlrev_b32 v68, 16, v38
  v_and_b32 v69, s20, v38
  v_add_f32 v20, v20, v68
  v_add_f32 v21, v21, v69
  v_lshlrev_b32 v68, 16, v39
  v_and_b32 v69, s20, v39
  v_add_f32 v22, v22, v68
  v_add_f32 v23, v23, v69
  s_waitcnt lgkmcnt(3)
  v_lshlrev_b32 v68, 16, v40
  v_and_b32 v69, s20, v40
  v_add_f32 v16, v16, v68
  v_add_f32 v17, v17, v69
  v_lshlrev_b32 v68, 16, v41
  v_and_b32 v69, s20, v41
  v_add_f32 v18, v18, v68
  v_add_f32 v19, v19, v69
  v_lshlrev_b32 v68, 16, v42
  v_and_b32 v69, s20, v42
  v_add_f32 v20, v20, v68
  v_add_f32 v21, v21, v69
  v_lshlrev_b32 v68, 16, v43
  v_and_b32 v69, s20, v43
  v_add_f32 v22, v22, v68
  v_add_f32 v23, v23, v69
  s_waitcnt lgkmcnt(2)
  v_lshlrev_b32 v68, 16, v44
  v_and_b32 v69, s20, v44
  v_add_f32 v16, v16, v68
  v_add_f32 v17, v17, v69
  v_lshlrev_b32 v68, 16, v45
  v_and_b32 v69, s20, v45
  v_add_f32 v18, v18, v68
  v_add_f32 v19, v19, v69
  v_lshlrev_b32 v68, 16, v46
  v_and_b32 v69, s20, v46
  v_add_f32 v20, v20, v68
  v_add_f32 v21, v21, v69
  v_lshlrev_b32 v68, 16, v47
  v_and_b32 v69, s20, v47
  v_add_f32 v22, v22, v68
  v_add_f32 v23, v23, v69
  s_waitcnt lgkmcnt(1)
  v_lshlrev_b32 v68, 16, v48
  v_and_b32 v69, s20, v48
  v_add_f32 v16, v16, v68
  v_add_f32 v17, v17, v69
  v_lshlrev_b32 v68, 16, v49
  v_and_b32 v69, s20, v49
  v_add_f32 v18, v18, v68
  v_add_f32 v19, v19, v69
  v_lshlrev_b32 v68, 16, v50
  v_and_b32 v69, s20, v50
  v_add_f32 v20, v20, v68
  v_add_f32 v21, v21, v69
  v_lshlrev_b32 v68, 16, v51
  v_and_b32 v69, s20, v51
  v_add_f32 v22, v22, v68
  v_add_f32 v23, v23, v69
  s_waitcnt lgkmcnt(0)
  v_lshlrev_b32 v68, 16, v52
  v_and_b32 v69, s20, v52
  v_add_f32 v16, v16, v68
  v_add_f32 v17, v17, v69
  v_lshlrev_b32 v68, 16, v53
  v_and_b32 v69, s20, v53
  v_add_f32 v18, v18, v68
  v_add_f32 v19, v19, v69
  v_lshlrev_b32 v68, 16, v54
  v_and_b32 v69, s20, v54
  v_add_f32 v20, v20, v68
  v_add_f32 v21, v21, v69
  v_lshlrev_b32 v68, 16, v55
  v_and_b32 v69, s20, v55
  v_add_f32 v22, v22, v68
  v_add_f32 v23, v23, v69
  s_add_u32 s32, s32, 53504
  s_cmp_eq_u32 s32, 160512
  s_cselect_b32 s32, 0, s32
  s_waitcnt vmcnt(5)
  ds_write_b32 v72, v74
  v_lshrrev_b32 v73, 16, v73
  v_xor_b32 v73, 0x8000, v73
  v_lshl_or_b32 v80, v73, 16, v73
  ds_write_b128 v77, v[80:83]
  v_add_f32_dpp v16, v16, v16 quad_perm:[1,0,3,2] row_mask:0xf bank_mask:0xf
  v_add_f32_dpp v17, v17, v17 quad_perm:[1,0,3,2] row_mask:0xf bank_mask:0xf
  v_add_f32_dpp v18, v18, v18 quad_perm:[1,0,3,2] row_mask:0xf bank_mask:0xf
  v_add_f32_dpp v19, v19, v19 quad_perm:[1,0,3,2] row_mask:0xf bank_mask:0xf
  v_add_f32_dpp v20, v20, v20 quad_perm:[1,0,3,2] row_mask:0xf bank_mask:0xf
  v_add_f32_dpp v21, v21, v21 quad_perm:[1,0,3,2] row_mask:0xf bank_mask:0xf
  v_add_f32_dpp v22, v22, v22 quad_perm:[1,0,3,2] row_mask:0xf bank_mask:0xf
  v_add_f32_dpp v23, v23, v23 quad_perm:[1,0,3,2] row_mask:0xf bank_mask:0xf
  v_add_f32_dpp v16, v16, v16 quad_perm:[2,3,0,1] row_mask:0xf bank_mask:0xf
  v_add_f32_dpp v17, v17, v17 quad_perm:[2,3,0,1] row_mask:0xf bank_mask:0xf
  v_add_f32_dpp v18, v18, v18 quad_perm:[2,3,0,1] row_mask:0xf bank_mask:0xf
  v_add_f32_dpp v19, v19, v19 quad_perm:[2,3,0,1] row_mask:0xf bank_mask:0xf
  v_add_f32_dpp v20, v20, v20 quad_perm:[2,3,0,1] row_mask:0xf bank_mask:0xf
  v_add_f32_dpp v21, v21, v21 quad_perm:[2,3,0,1] row_mask:0xf bank_mask:0xf
  v_add_f32_dpp v22, v22, v22 quad_perm:[2,3,0,1] row_mask:0xf bank_mask:0xf
  v_add_f32_dpp v23, v23, v23 quad_perm:[2,3,0,1] row_mask:0xf bank_mask:0xf
  v_add_f32_dpp v16, v16, v16 row_half_mirror row_mask:0xf bank_mask:0xf
  v_add_f32_dpp v17, v17, v17 row_half_mirror row_mask:0xf bank_mask:0xf
  v_add_f32_dpp v18, v18, v18 row_half_mirror row_mask:0xf bank_mask:0xf
  v_add_f32_dpp v19, v19, v19 row_half_mirror row_mask:0xf bank_mask:0xf
  v_add_f32_dpp v20, v20, v20 row_half_mirror row_mask:0xf bank_mask:0xf
  v_add_f32_dpp v21, v21, v21 row_half_mirror row_mask:0xf bank_mask:0xf
  v_add_f32_dpp v22, v22, v22 row_half_mirror row_mask:0xf bank_mask:0xf
  v_add_f32_dpp v23, v23, v23 row_half_mirror row_mask:0xf bank_mask:0xf
  v_cvt_pk_bf16_f32 v88, v16, v17
  v_cvt_pk_bf16_f32 v89, v18, v19
  v_cvt_pk_bf16_f32 v90, v20, v21
  v_cvt_pk_bf16_f32 v91, v22, v23
  v_lshlrev_b32 v68, 16, v88
  v_and_b32 v69, s20, v88
  v_sub_f32 v68, v16, v68
  v_sub_f32 v69, v17, v69
  v_cvt_pk_bf16_f32 v92, v68, v69
  v_lshlrev_b32 v68, 16, v89
  v_and_b32 v69, s20, v89
  v_sub_f32 v68, v18, v68
  v_sub_f32 v69, v19, v69
  v_cvt_pk_bf16_f32 v93, v68, v69
  v_lshlrev_b32 v68, 16, v90
  v_and_b32 v69, s20, v90
  v_sub_f32 v68, v20, v68
  v_sub_f32 v69, v21, v69
  v_cvt_pk_bf16_f32 v94, v68, v69
  v_lshlrev_b32 v68, 16, v91
  v_and_b32 v69, s20, v91
  v_sub_f32 v68, v22, v68
  v_sub_f32 v69, v23, v69
  v_cvt_pk_bf16_f32 v95, v68, v69
  s_mov_b32 s36, 0x01010101
  s_mov_b32 s37, 0x01010101
  s_mov_b32 s40, 0x02020202
  s_mov_b32 s41, 0x02020202
  v_cndmask_b32 v88, 0, v88, s[36:37]
  v_cndmask_b32 v88, v88, v92, s[40:41]
  v_cndmask_b32 v89, 0, v89, s[36:37]
  v_cndmask_b32 v89, v89, v93, s[40:41]
  v_cndmask_b32 v90, 0, v90, s[36:37]
  v_cndmask_b32 v90, v90, v94, s[40:41]
  v_cndmask_b32 v91, 0, v91, s[36:37]
  v_cndmask_b32 v91, v91, v95, s[40:41]
  ds_write_b128 v79, v[88:91]
  s_waitcnt lgkmcnt(0)
  s_barrier
  s_cmp_lt_u32 s28, 12
  s_cbranch_scc1 L1_copy
  v_lshrrev_b32 v66, 4, v1
  v_bfe_u32 v67, v1, 2, 2
  v_lshl_add_u32 v67, v66, 3, v67
  v_mul_u32_u24 v67, 160, v67
  v_and_b32 v66, 3, v1
  v_mul_u32_u24 v66, 40, v66
  v_add3_u32 v67, v67, v66, s39
  s_waitcnt vmcnt(0)
  ds_read_b64_tr_b16 v[160:161], v67 offset:0
  ds_read_b64_tr_b16 v[162:163], v67 offset:640
  ds_read_b64_tr_b16 v[164:165], v67 offset:8
  ds_read_b64_tr_b16 v[166:167], v67 offset:648
  ds_read_b64_tr_b16 v[168:169], v67 offset:16
  ds_read_b64_tr_b16 v[170:171], v67 offset:656
  ds_read_b64_tr_b16 v[172:173], v67 offset:24
  ds_read_b64_tr_b16 v[174:175], v67 offset:664
  ds_read_b64_tr_b16 v[176:177], v67 offset:32
  ds_read_b64_tr_b16 v[178:179], v67 offset:672
  s_branch L1_fin
L1_copy:
  s_cmp_ge_u32 s28, 4
  s_mov_b32 s37, 81920
  s_cselect_b32 s37, 163840, s37
  s_mov_b32 s38, 1280
  s_cselect_b32 s38, 2560, s38
  s_mov_b32 s36, 2621440
  s_cselect_b32 s36, 5242880, s36
  s_and_b32 s22, s28, 3
  s_lshl_b32 s22, s22, 3
  s_mul_i32 s22, s22, s37
  s_add_u32 s36, s36, s22
  s_lshl_b32 s21, s29, 3
  s_lshl_b32 s22, s30, 1
  s_add_u32 s21, s21, s22
  s_add_u32 s21, s21, 1
  s_mul_i32 s21, s21, s38
  s_add_u32 s36, s36, s21
  s_cmp_ge_u32 s28, 8
  s_cselect_b32 s21, 1280, 0
  s_add_u32 s36, s36, s21
  s_lshl_b32 s21, s37, 2
  s_add_u32 s38, s36, s21
  v_add_u32 v66, 0, v1
  v_mul_u32_u24 v67, 820, v66
  v_lshrrev_b32 v67, 16, v67
  v_mul_u32_u24 v68, 80, v67
  v_sub_u32 v66, v66, v68
  v_mul_lo_u32 v67, v67, s37
  v_lshl_add_u32 v104, v66, 4, v67
  v_add_u32 v66, 64, v1
  v_mul_u32_u24 v67, 820, v66
  v_lshrrev_b32 v67, 16, v67
  v_mul_u32_u24 v68, 80, v67
  v_sub_u32 v66, v66, v68
  v_mul_lo_u32 v67, v67, s37
  v_lshl_add_u32 v105, v66, 4, v67
  v_add_u32 v66, 128, v1
  v_mul_u32_u24 v67, 820, v66
  v_lshrrev_b32 v67, 16, v67
  v_mul_u32_u24 v68, 80, v67
  v_sub_u32 v66, v66, v68
  v_mul_lo_u32 v67, v67, s37
  v_lshl_add_u32 v106, v66, 4, v67
  v_add_u32 v66, 192, v1
  v_mul_u32_u24 v67, 820, v66
  v_lshrrev_b32 v67, 16, v67
  v_mul_u32_u24 v68, 80, v67
  v_sub_u32 v66, v66, v68
  v_mul_lo_u32 v67, v67, s37
  v_lshl_add_u32 v107, v66, 4, v67
  v_add_u32 v66, 256, v1
  v_mul_u32_u24 v67, 820, v66
  v_lshrrev_b32 v67, 16, v67
  v_mul_u32_u24 v68, 80, v67
  v_sub_u32 v66, v66, v68
  v_mul_lo_u32 v67, v67, s37
  v_lshl_add_u32 v108, v66, 4, v67
  s_mul_i32 s22, s30, 10240
  s_add_u32 s22, s22, 107008
  v_add_u32 v103, s22, v2
  s_mov_b32 s39, 0
  s_cmp_gt_u32 s39, 0
  s_cbranch_scc1 L1_cg0
L1_cw0:
  ds_read_b32 v102, v101
  s_waitcnt lgkmcnt(0)
  v_readfirstlane_b32 s39, v102
  s_nop 1
  s_cmp_gt_u32 s39, 0
  s_cbranch_scc0 L1_cw0
L1_cg0:
  ds_read_b128 v[112:115], v103 offset:0
  s_waitcnt lgkmcnt(0)
  buffer_store_dwordx4 v[112:115], v104, s[24:27], s36 offen sc1
  s_cmp_gt_u32 s39, 1
  s_cbranch_scc1 L1_cg1
L1_cw1:
  ds_read_b32 v102, v101
  s_waitcnt lgkmcnt(0)
  v_readfirstlane_b32 s39, v102
  s_nop 1
  s_cmp_gt_u32 s39, 1
  s_cbranch_scc0 L1_cw1
L1_cg1:
  ds_read_b128 v[116:119], v103 offset:1024
  s_waitcnt lgkmcnt(0)
  buffer_store_dwordx4 v[116:119], v105, s[24:27], s36 offen sc1
  s_cmp_gt_u32 s39, 2
  s_cbranch_scc1 L1_cg2
L1_cw2:
  ds_read_b32 v102, v101
  s_waitcnt lgkmcnt(0)
  v_readfirstlane_b32 s39, v102
  s_nop 1
  s_cmp_gt_u32 s39, 2
  s_cbranch_scc0 L1_cw2
L1_cg2:
  ds_read_b128 v[120:123], v103 offset:2048
  s_waitcnt lgkmcnt(0)
  buffer_store_dwordx4 v[120:123], v106, s[24:27], s36 offen sc1
  s_cmp_gt_u32 s39, 3
  s_cbranch_scc1 L1_cg3
L1_cw3:
  ds_read_b32 v102, v101
  s_waitcnt lgkmcnt(0)
  v_readfirstlane_b32 s39, v102
  s_nop 1
  s_cmp_gt_u32 s39, 3
  s_cbranch_scc0 L1_cw3
L1_cg3:
  ds_read_b128 v[124:127], v103 offset:3072
  s_waitcnt lgkmcnt(0)
  buffer_store_dwordx4 v[124:127], v107, s[24:27], s36 offen sc1
  s_cmp_gt_u32 s39, 4
  s_cbranch_scc1 L1_cg4
L1_cw4:
  ds_read_b32 v102, v101
  s_waitcnt lgkmcnt(0)
  v_readfirstlane_b32 s39, v102
  s_nop 1
  s_cmp_gt_u32 s39, 4
  s_cbranch_scc0 L1_cw4
L1_cg4:
  ds_read_b128 v[128:131], v103 offset:4096
  s_waitcnt lgkmcnt(0)
  buffer_store_dwordx4 v[128:131], v108, s[24:27], s36 offen sc1
  s_cmp_gt_u32 s39, 5
  s_cbranch_scc1 L1_cg5
L1_cw5:
  ds_read_b32 v102, v101
  s_waitcnt lgkmcnt(0)
  v_readfirstlane_b32 s39, v102
  s_nop 1
  s_cmp_gt_u32 s39, 5
  s_cbranch_scc0 L1_cw5
L1_cg5:
  ds_read_b128 v[132:135], v103 offset:5120
  s_waitcnt lgkmcnt(0)
  buffer_store_dwordx4 v[132:135], v104, s[24:27], s38 offen sc1
  s_cmp_gt_u32 s39, 6
  s_cbranch_scc1 L1_cg6
L1_cw6:
  ds_read_b32 v102, v101
  s_waitcnt lgkmcnt(0)
  v_readfirstlane_b32 s39, v102
  s_nop 1
  s_cmp_gt_u32 s39, 6
  s_cbranch_scc0 L1_cw6
L1_cg6:
  ds_read_b128 v[136:139], v103 offset:6144
  s_waitcnt lgkmcnt(0)
  buffer_store_dwordx4 v[136:139], v105, s[24:27], s38 offen sc1
  s_cmp_gt_u32 s39, 7
  s_cbranch_scc1 L1_cg7
L1_cw7:
  ds_read_b32 v102, v101
  s_waitcnt lgkmcnt(0)
  v_readfirstlane_b32 s39, v102
  s_nop 1
  s_cmp_gt_u32 s39, 7
  s_cbranch_scc0 L1_cw7
L1_cg7:
  ds_read_b128 v[140:143], v103 offset:7168
  s_waitcnt lgkmcnt(0)
  buffer_store_dwordx4 v[140:143], v106, s[24:27], s38 offen sc1
  s_cmp_gt_u32 s39, 8
  s_cbranch_scc1 L1_cg8
L1_cw8:
  ds_read_b32 v102, v101
  s_waitcnt lgkmcnt(0)
  v_readfirstlane_b32 s39, v102
  s_nop 1
  s_cmp_gt_u32 s39, 8
  s_cbranch_scc0 L1_cw8
L1_cg8:
  ds_read_b128 v[144:147], v103 offset:8192
  s_waitcnt lgkmcnt(0)
  buffer_store_dwordx4 v[144:147], v107, s[24:27], s38 offen sc1
  s_cmp_gt_u32 s39, 9
  s_cbranch_scc1 L1_cg9
L1_cw9:
  ds_read_b32 v102, v101
  s_waitcnt lgkmcnt(0)
  v_readfirstlane_b32 s39, v102
  s_nop 1
  s_cmp_gt_u32 s39, 9
  s_cbranch_scc0 L1_cw9
L1_cg9:
  ds_read_b128 v[148:151], v103 offset:9216
  s_waitcnt lgkmcnt(0)
  buffer_store_dwordx4 v[148:151], v108, s[24:27], s38 offen sc1
  s_branch L1_fin
L1_consumer:
  s_setprio 2
  s_lshl_b32 s37, s29, 8
  s_lshl_b32 s38, s28, 3
  s_add_u32 s37, s37, s38
  s_lshl_b32 s38, s3, 1
  s_add_u32 s51, s37, s38
  s_mul_i32 s37, s51, 1280
  s_cmp_ge_u32 s28, 12
  s_cbranch_scc1 L1_tab_ffn
  s_cmp_ge_u32 s28, 8
  s_cbranch_scc1 L1_tab_v
  s_mov_b32 s40, 0x03010200
  s_mov_b32 s41, 0x07050904
  s_mov_b32 s42, 0x0c0a0806
  s_mov_b32 s43, 0x130e0d0b
  s_mov_b32 s44, 0x1210110f
  s_mov_b32 s45, 0x17151614
  s_mov_b32 s46, 0x1b191d18
  s_mov_b32 s47, 0x201e1c1a
  s_mov_b32 s48, 0x2722211f
  s_mov_b32 s49, 0x26242523
  s_branch L1_tab_done
L1_tab_v:
  s_mov_b32 s40, 0x03020100
  s_mov_b32 s41, 0x07060504
  s_mov_b32 s42, 0x0b0a0908
  s_mov_b32 s43, 0x0f0e0d0c
  s_mov_b32 s44, 0x13121110
  s_mov_b32 s45, 0x17161514
  s_mov_b32 s46, 0x1b1a1918
  s_mov_b32 s47, 0x1f1e1d1c
  s_mov_b32 s48, 0x23222120
  s_mov_b32 s49, 0x27262524
  s_branch L1_tab_done
L1_tab_ffn:
  s_mov_b32 s40, 0x03010200
  s_mov_b32 s41, 0x17151614
  s_mov_b32 s42, 0x07050604
  s_mov_b32 s43, 0x1b191a18
  s_mov_b32 s44, 0x0b090a08
  s_mov_b32 s45, 0x1f1d1e1c
  s_mov_b32 s46, 0x0f0d0e0c
  s_mov_b32 s47, 0x23212220
  s_mov_b32 s48, 0x13111210
  s_mov_b32 s49, 0x27252624
L1_tab_done:
  s_waitcnt lgkmcnt(0)
  s_mov_b32 s52, s4
  s_mov_b32 s53, s5
  s_mov_b32 s54, 2621440
  s_mov_b32 s55, 0x00020000
  s_mov_b32 s24, s94
  s_mov_b32 s25, s95
  s_mov_b32 s26, 23756800
  s_mov_b32 s27, 0x00020000
  buffer_load_dwordx4 v[16:19], v4, s[52:55], s37 offen
  buffer_load_dwordx4 v[20:23], v4, s[52:55], s37 offen offset:640
  s_add_u32 s37, s37, 1280
  buffer_load_dwordx4 v[24:27], v4, s[52:55], s37 offen
  buffer_load_dwordx4 v[28:31], v4, s[52:55], s37 offen offset:640
  v_lshrrev_b32 v72, 4, v1
  v_and_b32 v73, 3, v1
  v_bfe_u32 v74, v1, 2, 2
  v_lshrrev_b32 v75, 1, v72
  v_lshl_add_u32 v74, v75, 3, v74
  v_mul_u32_u24 v74, 160, v74
  v_lshlrev_b32 v73, 3, v73
  v_and_b32 v72, 1, v72
  v_cmp_eq_u32 vcc, 1, v72
  v_mov_b32 v75, s40
  v_mov_b32 v76, s41
  v_cndmask_b32 v75, v75, v76, vcc
  v_bfe_u32 v75, v75, v73, 8
  v_cmp_lt_u32 s[22:23], 19, v75
  v_lshl_add_u32 v75, v75, 3, v74
  v_add_u32 v76, 10208, v75
  v_cndmask_b32 v5, v75, v76, s[22:23]
  v_mov_b32 v75, s42
  v_mov_b32 v76, s43
  v_cndmask_b32 v75, v75, v76, vcc
  v_bfe_u32 v75, v75, v73, 8
  v_cmp_lt_u32 s[22:23], 19, v75
  v_lshl_add_u32 v75, v75, 3, v74
  v_add_u32 v76, 10208, v75
  v_cndmask_b32 v6, v75, v76, s[22:23]
  v_mov_b32 v75, s44
  v_mov_b32 v76, s45
  v_cndmask_b32 v75, v75, v76, vcc
  v_bfe_u32 v75, v75, v73, 8
  v_cmp_lt_u32 s[22:23], 19, v75
  v_lshl_add_u32 v75, v75, 3, v74
  v_add_u32 v76, 10208, v75
  v_cndmask_b32 v7, v75, v76, s[22:23]
  v_mov_b32 v75, s46
  v_mov_b32 v76, s47
  v_cndmask_b32 v75, v75, v76, vcc
  v_bfe_u32 v75, v75, v73, 8
  v_cmp_lt_u32 s[22:23], 19, v75
  v_lshl_add_u32 v75, v75, 3, v74
  v_add_u32 v76, 10208, v75
  v_cndmask_b32 v8, v75, v76, s[22:23]
  v_mov_b32 v75, s48
  v_mov_b32 v76, s49
  v_cndmask_b32 v75, v75, v76, vcc
  v_bfe_u32 v75, v75, v73, 8
  v_cmp_lt_u32 s[22:23], 19, v75
  v_lshl_add_u32 v75, v75, 3, v74
  v_add_u32 v76, 10208, v75
  v_cndmask_b32 v9, v75, v76, s[22:23]
  v_and_b32 v72, 31, v1
  v_lshrrev_b32 v73, 5, v1
  v_bfe_u32 v74, v72, 1, 3
  v_xor_b32 v74, v74, v73
  v_lshlrev_b32 v74, 4, v74
  v_lshl_add_u32 v74, v72, 7, v74
  s_lshl_b32 s38, s3, 13
  s_add_u32 s38, s38, 20736
  v_xor_b32 v75, 0, v74
  v_add_u32 v10, s38, v75
  v_xor_b32 v75, 32, v74
  v_add_u32 v11, s38, v75
  v_xor_b32 v75, 64, v74
  v_add_u32 v12, s38, v75
  v_xor_b32 v75, 96, v74
  v_add_u32 v13, s38, v75
  v_mov_b32 v56, 0
  v_mov_b32 v57, 0
  v_mov_b32 v58, 0
  v_mov_b32 v59, 0
  s_nop 1
  v_mfma_f32_32x32x16_bf16 v[96:111], v[56:59], v[56:59], 0
  v_mfma_f32_32x32x16_bf16 v[112:127], v[56:59], v[56:59], 0
  v_mfma_f32_32x32x16_bf16 v[128:143], v[56:59], v[56:59], 0
  v_mfma_f32_32x32x16_bf16 v[144:159], v[56:59], v[56:59], 0
  v_mfma_f32_32x32x16_bf16 v[160:175], v[56:59], v[56:59], 0
  v_mfma_f32_32x32x16_bf16 v[176:191], v[56:59], v[56:59], 0
  v_mfma_f32_32x32x16_bf16 v[192:207], v[56:59], v[56:59], 0
  v_mfma_f32_32x32x16_bf16 v[208:223], v[56:59], v[56:59], 0
  v_mfma_f32_32x32x16_bf16 v[224:239], v[56:59], v[56:59], 0
  v_mfma_f32_32x32x16_bf16 v[240:255], v[56:59], v[56:59], 0
  s_mov_b32 s35, 0
  s_waitcnt vmcnt(2)
L1_st:
  v_lshlrev_b32 v32, 16, v16
  v_and_b32 v33, s20, v16
  v_lshlrev_b32 v34, 16, v17
  v_and_b32 v35, s20, v17
  v_lshlrev_b32 v36, 16, v18
  v_and_b32 v37, s20, v18
  v_lshlrev_b32 v38, 16, v19
  v_and_b32 v39, s20, v19
  v_lshlrev_b32 v40, 16, v20
  v_and_b32 v41, s20, v20
  v_lshlrev_b32 v42, 16, v21
  v_and_b32 v43, s20, v21
  v_lshlrev_b32 v44, 16, v22
  v_and_b32 v45, s20, v22
  v_lshlrev_b32 v46, 16, v23
  v_and_b32 v47, s20, v23
  v_add_f32 v72, v32, v33
  v_add_f32 v73, v34, v35
  v_add_f32 v72, v72, v36
  v_add_f32 v73, v73, v37
  v_add_f32 v72, v72, v38
  v_add_f32 v73, v73, v39
  v_add_f32 v72, v72, v40
  v_add_f32 v73, v73, v41
  v_add_f32 v72, v72, v42
  v_add_f32 v73, v73, v43
  v_add_f32 v72, v72, v44
  v_add_f32 v73, v73, v45
  v_add_f32 v72, v72, v46
  v_add_f32 v73, v73, v47
  v_add_f32 v72, v72, v73
  s_nop 1
  v_add_f32_dpp v72, v72, v72 row_ror:8 row_mask:0xf bank_mask:0xf
  s_nop 1
  v_add_f32_dpp v72, v72, v72 row_ror:4 row_mask:0xf bank_mask:0xf
  s_nop 1
  v_add_f32_dpp v72, v72, v72 row_ror:2 row_mask:0xf bank_mask:0xf
  s_nop 1
  v_add_f32_dpp v72, v72, v72 row_ror:1 row_mask:0xf bank_mask:0xf
  v_mov_b32 v73, v72
  s_nop 1
  v_permlane16_swap_b32 v72, v73
  v_add_f32 v72, v72, v73
  v_mov_b32 v73, v72
  s_nop 1
  v_permlane32_swap_b32 v72, v73
  v_add_f32 v72, v72, v73
  v_mul_f32 v72, 0x3acccccd, v72
  v_mov_b32 v73, 0
  v_mov_b32 v74, 0
  s_mov_b64 exec, s[86:87]
  v_sub_f32 v75, v32, v72
  v_sub_f32 v76, v33, v72
  v_fmac_f32 v73, v75, v75
  v_fmac_f32 v74, v76, v76
  v_sub_f32 v75, v34, v72
  v_sub_f32 v76, v35, v72
  v_fmac_f32 v73, v75, v75
  v_fmac_f32 v74, v76, v76
  v_sub_f32 v75, v36, v72
  v_sub_f32 v76, v37, v72
  v_fmac_f32 v73, v75, v75
  v_fmac_f32 v74, v76, v76
  v_sub_f32 v75, v38, v72
  v_sub_f32 v76, v39, v72
  v_fmac_f32 v73, v75, v75
  v_fmac_f32 v74, v76, v76
  v_sub_f32 v75, v40, v72
  v_sub_f32 v76, v41, v72
  v_fmac_f32 v73, v75, v75
  v_fmac_f32 v74, v76, v76
  v_sub_f32 v75, v42, v72
  v_sub_f32 v76, v43, v72
  v_fmac_f32 v73, v75, v75
  v_fmac_f32 v74, v76, v76
  v_sub_f32 v75, v44, v72
  v_sub_f32 v76, v45, v72
  v_fmac_f32 v73, v75, v75
  v_fmac_f32 v74, v76, v76
  v_sub_f32 v75, v46, v72
  v_sub_f32 v76, v47, v72
  v_fmac_f32 v73, v75, v75
  v_fmac_f32 v74, v76, v76
  s_mov_b64 exec, -1
  v_add_f32 v73, v73, v74
  s_nop 1
  v_add_f32_dpp v73, v73, v73 row_ror:8 row_mask:0xf bank_mask:0xf
  s_nop 1
  v_add_f32_dpp v73, v73, v73 row_ror:4 row_mask:0xf bank_mask:0xf
  s_nop 1
  v_add_f32_dpp v73, v73, v73 row_ror:2 row_mask:0xf bank_mask:0xf
  s_nop 1
  v_add_f32_dpp v73, v73, v73 row_ror:1 row_mask:0xf bank_mask:0xf
  v_mov_b32 v74, v73
  s_nop 1
  v_permlane16_swap_b32 v73, v74
  v_add_f32 v73, v73, v74
  v_mov_b32 v74, v73
  s_nop 1
  v_permlane32_swap_b32 v73, v74
  v_add_f32 v73, v73, v74
  v_mul_f32 v73, 0x3acccccd, v73
  v_cvt_pk_bf16_f32 v74, v72, v73
  v_lshlrev_b32 v72, 16, v74
  v_and_b32 v73, s20, v74
  v_add_f32 v73, 0x3727c5ac, v73
  v_cvt_pk_bf16_f32 v73, v73, v73
  v_and_b32 v73, s20, v73
  v_sqrt_f32 v73, v73
  s_nop 0
  v_cvt_pk_bf16_f32 v73, v73, v73
  v_and_b32 v73, s20, v73
  v_rcp_f32 v73, v73
  v_cmp_eq_u32 vcc, 0, v1
  v_lshlrev_b32 v74, 13, v1
  s_lshl_b32 s37, s51, 2
  v_cndmask_b32 v72, v73, v72, vcc
  s_mov_b64 exec, 3
  buffer_store_dword v72, v74, s[24:27], s37 offen offset:0 sc1
  s_mov_b64 exec, -1
  s_add_u32 s51, s51, 1
  s_waitcnt vmcnt(1)
  v_mov_b32 v16, v24
  v_mov_b32 v17, v25
  v_mov_b32 v18, v26
  v_mov_b32 v19, v27
  v_mov_b32 v20, v28
  v_mov_b32 v21, v29
  v_mov_b32 v22, v30
  v_mov_b32 v23, v31
  s_add_u32 s35, s35, 1
  s_cmp_lt_u32 s35, 2
  s_cbranch_scc1 L1_st
  s_sub_u32 s38, s28, 8
  s_cmp_ge_u32 s38, 4
  s_cbranch_scc1 L1_novof
  s_mov_b32 s38, 163840
  s_mov_b32 s39, 0x43120
  s_mov_b32 s21, 0x31204
  s_mul_i32 s22, s3, 10240
  s_add_u32 s22, s22, 107008
  v_and_b32 v80, 31, v1
  v_lshrrev_b32 v81, 5, v1
  v_mul_u32_u24 v81, 320, v81
  v_add_u32 v82, 0, v80
  v_mul_u32_u24 v83, 3277, v82
  v_lshrrev_b32 v83, 16, v83
  v_mul_u32_u24 v84, 20, v83
  v_sub_u32 v84, v82, v84
  v_and_b32 v85, 1, v83
  v_cmp_eq_u32 vcc, 1, v85
  v_mov_b32 v85, s39
  v_mov_b32 v86, s21
  v_cndmask_b32 v85, v85, v86, vcc
  v_and_b32 v86, 28, v84
  v_bfe_u32 v85, v85, v86, 4
  v_and_b32 v84, 3, v84
  v_lshl_add_u32 v84, v85, 2, v84
  v_lshl_add_u32 v84, v84, 4, v81
  v_mul_u32_u24 v85, 1280, v83
  v_add3_u32 v91, v85, v84, s22
  v_mul_lo_u32 v83, v83, s38
  v_add_u32 v72, v83, v84
  v_add_u32 v82, 32, v80
  v_mul_u32_u24 v83, 3277, v82
  v_lshrrev_b32 v83, 16, v83
  v_mul_u32_u24 v84, 20, v83
  v_sub_u32 v84, v82, v84
  v_and_b32 v85, 1, v83
  v_cmp_eq_u32 vcc, 1, v85
  v_mov_b32 v85, s39
  v_mov_b32 v86, s21
  v_cndmask_b32 v85, v85, v86, vcc
  v_and_b32 v86, 28, v84
  v_bfe_u32 v85, v85, v86, 4
  v_and_b32 v84, 3, v84
  v_lshl_add_u32 v84, v85, 2, v84
  v_lshl_add_u32 v84, v84, 4, v81
  v_mul_u32_u24 v85, 1280, v83
  v_add3_u32 v92, v85, v84, s22
  v_mul_lo_u32 v83, v83, s38
  v_add_u32 v73, v83, v84
  v_add_u32 v82, 64, v80
  v_mul_u32_u24 v83, 3277, v82
  v_lshrrev_b32 v83, 16, v83
  v_mul_u32_u24 v84, 20, v83
  v_sub_u32 v84, v82, v84
  v_and_b32 v85, 1, v83
  v_cmp_eq_u32 vcc, 1, v85
  v_mov_b32 v85, s39
  v_mov_b32 v86, s21
  v_cndmask_b32 v85, v85, v86, vcc
  v_and_b32 v86, 28, v84
  v_bfe_u32 v85, v85, v86, 4
  v_and_b32 v84, 3, v84
  v_lshl_add_u32 v84, v85, 2, v84
  v_lshl_add_u32 v84, v84, 4, v81
  v_mul_u32_u24 v85, 1280, v83
  v_add3_u32 v93, v85, v84, s22
  v_mul_lo_u32 v83, v83, s38
  v_add_u32 v74, v83, v84
  v_add_u32 v82, 96, v80
  v_mul_u32_u24 v83, 3277, v82
  v_lshrrev_b32 v83, 16, v83
  v_mul_u32_u24 v84, 20, v83
  v_sub_u32 v84, v82, v84
  v_and_b32 v85, 1, v83
  v_cmp_eq_u32 vcc, 1, v85
  v_mov_b32 v85, s39
  v_mov_b32 v86, s21
  v_cndmask_b32 v85, v85, v86, vcc
  v_and_b32 v86, 28, v84
  v_bfe_u32 v85, v85, v86, 4
  v_and_b32 v84, 3, v84
  v_lshl_add_u32 v84, v85, 2, v84
  v_lshl_add_u32 v84, v84, 4, v81
  v_mul_u32_u24 v85, 1280, v83
  v_add3_u32 v94, v85, v84, s22
  v_mul_lo_u32 v83, v83, s38
  v_add_u32 v75, v83, v84
  v_add_u32 v82, 128, v80
  v_mul_u32_u24 v83, 3277, v82
  v_lshrrev_b32 v83, 16, v83
  v_mul_u32_u24 v84, 20, v83
  v_sub_u32 v84, v82, v84
  v_and_b32 v85, 1, v83
  v_cmp_eq_u32 vcc, 1, v85
  v_mov_b32 v85, s39
  v_mov_b32 v86, s21
  v_cndmask_b32 v85, v85, v86, vcc
  v_and_b32 v86, 28, v84
  v_bfe_u32 v85, v85, v86, 4
  v_and_b32 v84, 3, v84
  v_lshl_add_u32 v84, v85, 2, v84
  v_lshl_add_u32 v84, v84, 4, v81
  v_mul_u32_u24 v85, 1280, v83
  v_add3_u32 v95, v85, v84, s22
  v_mul_lo_u32 v83, v83, s38
  v_add_u32 v76, v83, v84
L1_novof:
  s_mov_b32 s60, s92
  s_mov_b32 s61, s93
  s_mov_b32 s62, 256
  s_mov_b32 s63, 0x00020000
  v_mov_b32 v77, 0x40000000
  buffer_load_dword v86, v77, s[60:63], 0 offen
  buffer_load_dword v87, v77, s[60:63], 0 offen
  s_sub_u32 s83, s2, 96
  s_lshl_b32 s83, s83, 2
  s_add_u32 s83, s83, s30
  s_lshr_b32 s37, s83, 3
  s_and_b32 s38, s83, 7
  s_mul_i32 s39, s38, 160
  s_cmp_lt_u32 s37, 20
  s_cselect_b32 s56, s96, s76
  s_cselect_b32 s57, s97, s77
  s_mov_b32 s58, 1966080
  s_cselect_b32 s58, 819200, s58
  s_cselect_b32 s85, 0, 20
  s_mov_b32 s59, 0x00020000
  s_sub_u32 s85, s37, s85
  s_mul_i32 s85, s85, 40960
  s_add_u32 s85, s85, s39
  s_cmp_lt_u32 s83, 544
  s_cselect_b32 s85, s85, 0x40000000
  v_lshrrev_b32 v3, 1, v1
  v_mul_u32_u24 v3, 1280, v3
  v_and_b32 v4, 1, v1
  v_mul_u32_u24 v4, 156, v4
  v_add_u32 v3, v3, v4
  s_cmp_eq_u32 s3, 0
  s_cselect_b32 s84, 1, 5
  s_cselect_b32 s83, 7, 99
  s_mov_b32 s35, 0
  s_mov_b32 s32, 53504
  s_mov_b32 s33, 0
  s_barrier
  ds_read_b128 v[56:59], v10
  ds_read_b128 v[60:63], v10 offset:4096
  ds_read_b64_tr_b16 v[16:17], v5
  ds_read_b64_tr_b16 v[18:19], v5 offset:640
  ds_read_b64_tr_b16 v[20:21], v6
  ds_read_b64_tr_b16 v[22:23], v6 offset:640
  ds_read_b64_tr_b16 v[24:25], v7
  ds_read_b64_tr_b16 v[26:27], v7 offset:640
  ds_read_b64_tr_b16 v[28:29], v8
  ds_read_b64_tr_b16 v[30:31], v8 offset:640
  ds_read_b64_tr_b16 v[32:33], v9
  ds_read_b64_tr_b16 v[34:35], v9 offset:640
  s_cmp_ge_u32 s28, 8
  s_cbranch_scc0 L1_loopA
  s_cmp_lt_u32 s28, 12
  s_cbranch_scc1 L1_loopB
  .p2align 6
L1_loopA:
  s_cmp_eq_u32 s35, s84
  s_cbranch_scc1 L1_sideA
L1_backA:
  s_waitcnt lgkmcnt(8)
  v_mfma_f32_32x32x16_bf16 v[96:111], v[16:19], v[56:59], v[96:111]
  ds_read_b128 v[64:67], v11
  ds_read_b128 v[68:71], v11 offset:4096
  v_mfma_f32_32x32x16_bf16 v[176:191], v[16:19], v[60:63], v[176:191]
  ds_read_b64_tr_b16 v[36:37], v5 offset:2560
  ds_read_b64_tr_b16 v[38:39], v5 offset:3200
  s_waitcnt lgkmcnt(10)
  v_mfma_f32_32x32x16_bf16 v[112:127], v[20:23], v[56:59], v[112:127]
  ds_read_b64_tr_b16 v[40:41], v6 offset:2560
  ds_read_b64_tr_b16 v[42:43], v6 offset:3200
  v_mfma_f32_32x32x16_bf16 v[192:207], v[20:23], v[60:63], v[192:207]
  ds_read_b64_tr_b16 v[44:45], v7 offset:2560
  ds_read_b64_tr_b16 v[46:47], v7 offset:3200
  s_waitcnt lgkmcnt(12)
  v_mfma_f32_32x32x16_bf16 v[128:143], v[24:27], v[56:59], v[128:143]
  ds_read_b64_tr_b16 v[48:49], v8 offset:2560
  ds_read_b64_tr_b16 v[50:51], v8 offset:3200
  v_mfma_f32_32x32x16_bf16 v[208:223], v[24:27], v[60:63], v[208:223]
  ds_read_b64_tr_b16 v[52:53], v9 offset:2560
  ds_read_b64_tr_b16 v[54:55], v9 offset:3200
  s_waitcnt lgkmcnt(14)
  v_mfma_f32_32x32x16_bf16 v[144:159], v[28:31], v[56:59], v[144:159]
  v_mfma_f32_32x32x16_bf16 v[224:239], v[28:31], v[60:63], v[224:239]
  s_waitcnt lgkmcnt(12)
  v_mfma_f32_32x32x16_bf16 v[160:175], v[32:35], v[56:59], v[160:175]
  v_mfma_f32_32x32x16_bf16 v[240:255], v[32:35], v[60:63], v[240:255]
  s_waitcnt lgkmcnt(8)
  v_mfma_f32_32x32x16_bf16 v[96:111], v[36:39], v[64:67], v[96:111]
  ds_read_b128 v[56:59], v12
  ds_read_b128 v[60:63], v12 offset:4096
  v_mfma_f32_32x32x16_bf16 v[176:191], v[36:39], v[68:71], v[176:191]
  ds_read_b64_tr_b16 v[16:17], v5 offset:5120
  ds_read_b64_tr_b16 v[18:19], v5 offset:5760
  s_waitcnt lgkmcnt(10)
  v_mfma_f32_32x32x16_bf16 v[112:127], v[40:43], v[64:67], v[112:127]
  ds_read_b64_tr_b16 v[20:21], v6 offset:5120
  ds_read_b64_tr_b16 v[22:23], v6 offset:5760
  v_mfma_f32_32x32x16_bf16 v[192:207], v[40:43], v[68:71], v[192:207]
  ds_read_b64_tr_b16 v[24:25], v7 offset:5120
  ds_read_b64_tr_b16 v[26:27], v7 offset:5760
  s_waitcnt lgkmcnt(12)
  v_mfma_f32_32x32x16_bf16 v[128:143], v[44:47], v[64:67], v[128:143]
  ds_read_b64_tr_b16 v[28:29], v8 offset:5120
  ds_read_b64_tr_b16 v[30:31], v8 offset:5760
  v_mfma_f32_32x32x16_bf16 v[208:223], v[44:47], v[68:71], v[208:223]
  ds_read_b64_tr_b16 v[32:33], v9 offset:5120
  ds_read_b64_tr_b16 v[34:35], v9 offset:5760
  s_waitcnt lgkmcnt(14)
  v_mfma_f32_32x32x16_bf16 v[144:159], v[48:51], v[64:67], v[144:159]
  v_mfma_f32_32x32x16_bf16 v[224:239], v[48:51], v[68:71], v[224:239]
  s_waitcnt lgkmcnt(12)
  v_mfma_f32_32x32x16_bf16 v[160:175], v[52:55], v[64:67], v[160:175]
  v_mfma_f32_32x32x16_bf16 v[240:255], v[52:55], v[68:71], v[240:255]
  s_waitcnt lgkmcnt(8)
  v_mfma_f32_32x32x16_bf16 v[96:111], v[16:19], v[56:59], v[96:111]
  ds_read_b128 v[64:67], v13
  ds_read_b128 v[68:71], v13 offset:4096
  v_mfma_f32_32x32x16_bf16 v[176:191], v[16:19], v[60:63], v[176:191]
  ds_read_b64_tr_b16 v[36:37], v5 offset:7680
  ds_read_b64_tr_b16 v[38:39], v5 offset:8320
  s_waitcnt lgkmcnt(10)
  v_mfma_f32_32x32x16_bf16 v[112:127], v[20:23], v[56:59], v[112:127]
  ds_read_b64_tr_b16 v[40:41], v6 offset:7680
  ds_read_b64_tr_b16 v[42:43], v6 offset:8320
  v_mfma_f32_32x32x16_bf16 v[192:207], v[20:23], v[60:63], v[192:207]
  ds_read_b64_tr_b16 v[44:45], v7 offset:7680
  ds_read_b64_tr_b16 v[46:47], v7 offset:8320
  s_waitcnt lgkmcnt(12)
  v_mfma_f32_32x32x16_bf16 v[128:143], v[24:27], v[56:59], v[128:143]
  ds_read_b64_tr_b16 v[48:49], v8 offset:7680
  ds_read_b64_tr_b16 v[50:51], v8 offset:8320
  v_mfma_f32_32x32x16_bf16 v[208:223], v[24:27], v[60:63], v[208:223]
  ds_read_b64_tr_b16 v[52:53], v9 offset:7680
  ds_read_b64_tr_b16 v[54:55], v9 offset:8320
  s_waitcnt lgkmcnt(14)
  v_mfma_f32_32x32x16_bf16 v[144:159], v[28:31], v[56:59], v[144:159]
  v_mfma_f32_32x32x16_bf16 v[224:239], v[28:31], v[60:63], v[224:239]
  s_waitcnt lgkmcnt(12)
  v_mfma_f32_32x32x16_bf16 v[160:175], v[32:35], v[56:59], v[160:175]
  v_add_u32 v10, s32, v10
  v_mfma_f32_32x32x16_bf16 v[240:255], v[32:35], v[60:63], v[240:255]
  s_waitcnt vmcnt(2) lgkmcnt(0)
  v_mfma_f32_32x32x16_bf16 v[96:111], v[36:39], v[64:67], v[96:111]
  s_barrier
  ds_read_b128 v[56:59], v10
  ds_read_b128 v[60:63], v10 offset:4096
  v_mfma_f32_32x32x16_bf16 v[176:191], v[36:39], v[68:71], v[176:191]
  v_add_u32 v5, s32, v5
  ds_read_b64_tr_b16 v[16:17], v5 offset:0
  ds_read_b64_tr_b16 v[18:19], v5 offset:640
  v_mfma_f32_32x32x16_bf16 v[112:127], v[40:43], v[64:67], v[112:127]
  v_add_u32 v6, s32, v6
  ds_read_b64_tr_b16 v[20:21], v6 offset:0
  ds_read_b64_tr_b16 v[22:23], v6 offset:640
  v_mfma_f32_32x32x16_bf16 v[192:207], v[40:43], v[68:71], v[192:207]
  v_add_u32 v7, s32, v7
  ds_read_b64_tr_b16 v[24:25], v7 offset:0
  ds_read_b64_tr_b16 v[26:27], v7 offset:640
  v_mfma_f32_32x32x16_bf16 v[128:143], v[44:47], v[64:67], v[128:143]
  v_add_u32 v8, s32, v8
  ds_read_b64_tr_b16 v[28:29], v8 offset:0
  ds_read_b64_tr_b16 v[30:31], v8 offset:640
  v_mfma_f32_32x32x16_bf16 v[208:223], v[44:47], v[68:71], v[208:223]
  v_add_u32 v9, s32, v9
  ds_read_b64_tr_b16 v[32:33], v9 offset:0
  ds_read_b64_tr_b16 v[34:35], v9 offset:640
  v_mfma_f32_32x32x16_bf16 v[144:159], v[48:51], v[64:67], v[144:159]
  v_mfma_f32_32x32x16_bf16 v[224:239], v[48:51], v[68:71], v[224:239]
  v_add_u32 v11, s32, v11
  v_mfma_f32_32x32x16_bf16 v[160:175], v[52:55], v[64:67], v[160:175]
  v_add_u32 v12, s32, v12
  v_mfma_f32_32x32x16_bf16 v[240:255], v[52:55], v[68:71], v[240:255]
  v_add_u32 v13, s32, v13
  s_add_u32 s33, s33, 1
  s_cmp_eq_u32 s33, 2
  s_mov_b32 s32, 53504
  s_cselect_b32 s32, 4294860288, s32
  s_cmp_eq_u32 s33, 3
  s_cselect_b32 s33, 0, s33
  s_add_u32 s35, s35, 1
  s_cmp_lt_u32 s35, 10
  s_cbranch_scc1 L1_loopA
  s_waitcnt vmcnt(0) lgkmcnt(0)
  v_mfma_f32_32x32x16_bf16 v[96:111], v[16:19], v[56:59], v[96:111]
  s_cmp_lg_u32 s3, 0
  s_cbranch_scc1 L1_nononA
  s_mov_b32 s86, 20000
  v_mov_b32 v15, 0
L1_nwA:
  v_readfirstlane_b32 s87, v14
  s_nop 1
  s_cmp_lg_u32 s87, 0
  s_cbranch_scc1 L1_nokA
  buffer_load_dword v14, v15, s[60:63], 0 offen offset:24 sc1
  s_sub_u32 s86, s86, 1
  s_cmp_gt_i32 s86, 0
  s_waitcnt vmcnt(0)
  s_cbranch_scc1 L1_nwA
L1_nokA:
  v_mov_b32 v14, s87
  v_mov_b32 v15, 163000
  ds_write_b32 v15, v14
L1_nononA:
  v_and_b32 v10, 31, v1
  v_lshrrev_b32 v11, 5, v1
  s_lshl_b32 s38, s3, 8
  s_add_u32 s38, s38, 160512
  s_lshl_b32 s21, s29, 3
  s_lshl_b32 s22, s3, 1
  s_add_u32 s21, s21, s22
  v_lshlrev_b32 v12, 2, v10
  v_add_u32 v12, s38, v12
  ds_read_b32 v4, v12
  ds_read_b32 v6, v12 offset:128
  v_mfma_f32_32x32x16_bf16 v[176:191], v[16:19], v[60:63], v[176:191]
  v_mfma_f32_32x32x16_bf16 v[112:127], v[20:23], v[56:59], v[112:127]
  v_mfma_f32_32x32x16_bf16 v[192:207], v[20:23], v[60:63], v[192:207]
  v_mfma_f32_32x32x16_bf16 v[128:143], v[24:27], v[56:59], v[128:143]
  v_mfma_f32_32x32x16_bf16 v[208:223], v[24:27], v[60:63], v[208:223]
  v_mfma_f32_32x32x16_bf16 v[144:159], v[28:31], v[56:59], v[144:159]
  v_mfma_f32_32x32x16_bf16 v[224:239], v[28:31], v[60:63], v[224:239]
  v_mfma_f32_32x32x16_bf16 v[160:175], v[32:35], v[56:59], v[160:175]
  v_mfma_f32_32x32x16_bf16 v[240:255], v[32:35], v[60:63], v[240:255]
  s_cmp_ge_u32 s28, 12
  s_cbranch_scc1 L1_epi_ffn
  s_cmp_ge_u32 s28, 4
  s_mov_b32 s37, 81920
  s_cselect_b32 s37, 163840, s37
  s_mov_b32 s38, 1280
  s_cselect_b32 s38, 2560, s38
  s_mov_b32 s36, 2621440
  s_cselect_b32 s36, 5242880, s36
  s_cselect_b32 s22, 1.0, 0x3ea52b5c
  s_waitcnt lgkmcnt(0)
  v_mul_f32 v4, s22, v4
  v_mov_b32 v5, v4
  v_mul_f32 v6, s22, v6
  v_mov_b32 v7, v6
  s_and_b32 s22, s28, 3
  s_lshl_b32 s22, s22, 3
  s_mul_i32 s23, s22, s37
  s_add_u32 s36, s36, s23
  s_mul_i32 s23, s21, s38
  s_add_u32 s36, s36, s23
  v_mul_lo_u32 v3, v11, s37
  v_lshl_add_u32 v3, v10, 3, v3
  v_add_u32 v3, 1024, v3
  s_mul_i32 s22, s3, 10240
  s_add_u32 s22, s22, 107008
  v_add_u32 v8, s22, v2
  v_mul_u32_u24 v9, 1280, v11
  v_lshl_add_u32 v9, v10, 3, v9
  v_add_u32 v9, s22, v9
  s_lshl_b32 s22, s3, 2
  s_add_u32 s22, s22, 161536
  v_mov_b32 v12, s22
  s_add_u32 s23, s36, s37
  v_pk_mul_f32 v[176:177], v[176:177], v[6:7]
  v_pk_mul_f32 v[178:179], v[178:179], v[6:7]
  v_pk_mul_f32 v[180:181], v[180:181], v[6:7]
  v_pk_mul_f32 v[182:183], v[182:183], v[6:7]
  v_cvt_pk_bf16_f32 v26, v176, v177
  v_cvt_pk_bf16_f32 v27, v178, v179
  v_cvt_pk_bf16_f32 v28, v180, v181
  v_cvt_pk_bf16_f32 v29, v182, v183
  ds_write_b128 v8, v[26:29] offset:0
  v_pk_mul_f32 v[184:185], v[184:185], v[6:7]
  v_pk_mul_f32 v[186:187], v[186:187], v[6:7]
  v_cvt_pk_bf16_f32 v34, v184, v185
  v_cvt_pk_bf16_f32 v35, v186, v187
  ds_write_b64 v9, v[34:35] offset:1024
  v_pk_mul_f32 v[188:189], v[188:189], v[6:7]
  v_pk_mul_f32 v[190:191], v[190:191], v[6:7]
  v_pk_mul_f32 v[192:193], v[192:193], v[6:7]
  v_pk_mul_f32 v[194:195], v[194:195], v[6:7]
  v_cvt_pk_bf16_f32 v30, v188, v189
  v_cvt_pk_bf16_f32 v31, v190, v191
  v_cvt_pk_bf16_f32 v32, v192, v193
  v_cvt_pk_bf16_f32 v33, v194, v195
  ds_write_b128 v8, v[30:33] offset:1280
  v_mov_b32 v13, 2
  ds_write_b32 v12, v13
  v_pk_mul_f32 v[96:97], v[96:97], v[4:5]
  v_pk_mul_f32 v[98:99], v[98:99], v[4:5]
  v_pk_mul_f32 v[100:101], v[100:101], v[4:5]
  v_pk_mul_f32 v[102:103], v[102:103], v[4:5]
  v_cvt_pk_bf16_f32 v16, v96, v97
  v_cvt_pk_bf16_f32 v17, v98, v99
  v_cvt_pk_bf16_f32 v18, v100, v101
  v_cvt_pk_bf16_f32 v19, v102, v103
  buffer_store_dwordx4 v[16:19], v2, s[24:27], s36 offen sc1
  v_pk_mul_f32 v[104:105], v[104:105], v[4:5]
  v_pk_mul_f32 v[106:107], v[106:107], v[4:5]
  v_cvt_pk_bf16_f32 v24, v104, v105
  v_cvt_pk_bf16_f32 v25, v106, v107
  buffer_store_dwordx2 v[24:25], v3, s[24:27], s36 offen sc1
  v_pk_mul_f32 v[108:109], v[108:109], v[4:5]
  v_pk_mul_f32 v[110:111], v[110:111], v[4:5]
  v_pk_mul_f32 v[112:113], v[112:113], v[4:5]
  v_pk_mul_f32 v[114:115], v[114:115], v[4:5]
  v_cvt_pk_bf16_f32 v20, v108, v109
  v_cvt_pk_bf16_f32 v21, v110, v111
  v_cvt_pk_bf16_f32 v22, v112, v113
  v_cvt_pk_bf16_f32 v23, v114, v115
  buffer_store_dwordx4 v[20:23], v2, s[24:27], s23 offen sc1
  s_add_u32 s36, s23, s37
  s_add_u32 s23, s36, s37
  v_pk_mul_f32 v[196:197], v[196:197], v[6:7]
  v_pk_mul_f32 v[198:199], v[198:199], v[6:7]
  v_pk_mul_f32 v[200:201], v[200:201], v[6:7]
  v_pk_mul_f32 v[202:203], v[202:203], v[6:7]
  v_cvt_pk_bf16_f32 v46, v196, v197
  v_cvt_pk_bf16_f32 v47, v198, v199
  v_cvt_pk_bf16_f32 v48, v200, v201
  v_cvt_pk_bf16_f32 v49, v202, v203
  ds_write_b128 v8, v[46:49] offset:2560
  v_pk_mul_f32 v[204:205], v[204:205], v[6:7]
  v_pk_mul_f32 v[206:207], v[206:207], v[6:7]
  v_cvt_pk_bf16_f32 v54, v204, v205
  v_cvt_pk_bf16_f32 v55, v206, v207
  ds_write_b64 v9, v[54:55] offset:3584
  v_pk_mul_f32 v[208:209], v[208:209], v[6:7]
  v_pk_mul_f32 v[210:211], v[210:211], v[6:7]
  v_pk_mul_f32 v[212:213], v[212:213], v[6:7]
  v_pk_mul_f32 v[214:215], v[214:215], v[6:7]
  v_cvt_pk_bf16_f32 v50, v208, v209
  v_cvt_pk_bf16_f32 v51, v210, v211
  v_cvt_pk_bf16_f32 v52, v212, v213
  v_cvt_pk_bf16_f32 v53, v214, v215
  ds_write_b128 v8, v[50:53] offset:3840
  v_mov_b32 v13, 5
  ds_write_b32 v12, v13
  v_pk_mul_f32 v[116:117], v[116:117], v[4:5]
  v_pk_mul_f32 v[118:119], v[118:119], v[4:5]
  v_pk_mul_f32 v[120:121], v[120:121], v[4:5]
  v_pk_mul_f32 v[122:123], v[122:123], v[4:5]
  v_cvt_pk_bf16_f32 v36, v116, v117
  v_cvt_pk_bf16_f32 v37, v118, v119
  v_cvt_pk_bf16_f32 v38, v120, v121
  v_cvt_pk_bf16_f32 v39, v122, v123
  buffer_store_dwordx4 v[36:39], v2, s[24:27], s36 offen sc1
  v_pk_mul_f32 v[124:125], v[124:125], v[4:5]
  v_pk_mul_f32 v[126:127], v[126:127], v[4:5]
  v_cvt_pk_bf16_f32 v44, v124, v125
  v_cvt_pk_bf16_f32 v45, v126, v127
  buffer_store_dwordx2 v[44:45], v3, s[24:27], s36 offen sc1
  v_pk_mul_f32 v[128:129], v[128:129], v[4:5]
  v_pk_mul_f32 v[130:131], v[130:131], v[4:5]
  v_pk_mul_f32 v[132:133], v[132:133], v[4:5]
  v_pk_mul_f32 v[134:135], v[134:135], v[4:5]
  v_cvt_pk_bf16_f32 v40, v128, v129
  v_cvt_pk_bf16_f32 v41, v130, v131
  v_cvt_pk_bf16_f32 v42, v132, v133
  v_cvt_pk_bf16_f32 v43, v134, v135
  buffer_store_dwordx4 v[40:43], v2, s[24:27], s23 offen sc1
  s_add_u32 s36, s23, s37
  s_add_u32 s23, s36, s37
  v_pk_mul_f32 v[216:217], v[216:217], v[6:7]
  v_pk_mul_f32 v[218:219], v[218:219], v[6:7]
  v_pk_mul_f32 v[220:221], v[220:221], v[6:7]
  v_pk_mul_f32 v[222:223], v[222:223], v[6:7]
  v_cvt_pk_bf16_f32 v66, v216, v217
  v_cvt_pk_bf16_f32 v67, v218, v219
  v_cvt_pk_bf16_f32 v68, v220, v221
  v_cvt_pk_bf16_f32 v69, v222, v223
  ds_write_b128 v8, v[66:69] offset:5120
  v_pk_mul_f32 v[224:225], v[224:225], v[6:7]
  v_pk_mul_f32 v[226:227], v[226:227], v[6:7]
  v_cvt_pk_bf16_f32 v74, v224, v225
  v_cvt_pk_bf16_f32 v75, v226, v227
  ds_write_b64 v9, v[74:75] offset:6144
  v_pk_mul_f32 v[228:229], v[228:229], v[6:7]
  v_pk_mul_f32 v[230:231], v[230:231], v[6:7]
  v_pk_mul_f32 v[232:233], v[232:233], v[6:7]
  v_pk_mul_f32 v[234:235], v[234:235], v[6:7]
  v_cvt_pk_bf16_f32 v70, v228, v229
  v_cvt_pk_bf16_f32 v71, v230, v231
  v_cvt_pk_bf16_f32 v72, v232, v233
  v_cvt_pk_bf16_f32 v73, v234, v235
  ds_write_b128 v8, v[70:73] offset:6400
  v_mov_b32 v13, 7
  ds_write_b32 v12, v13
  v_pk_mul_f32 v[136:137], v[136:137], v[4:5]
  v_pk_mul_f32 v[138:139], v[138:139], v[4:5]
  v_pk_mul_f32 v[140:141], v[140:141], v[4:5]
  v_pk_mul_f32 v[142:143], v[142:143], v[4:5]
  v_cvt_pk_bf16_f32 v56, v136, v137
  v_cvt_pk_bf16_f32 v57, v138, v139
  v_cvt_pk_bf16_f32 v58, v140, v141
  v_cvt_pk_bf16_f32 v59, v142, v143
  buffer_store_dwordx4 v[56:59], v2, s[24:27], s36 offen sc1
  v_pk_mul_f32 v[144:145], v[144:145], v[4:5]
  v_pk_mul_f32 v[146:147], v[146:147], v[4:5]
  v_cvt_pk_bf16_f32 v64, v144, v145
  v_cvt_pk_bf16_f32 v65, v146, v147
  buffer_store_dwordx2 v[64:65], v3, s[24:27], s36 offen sc1
  v_pk_mul_f32 v[148:149], v[148:149], v[4:5]
  v_pk_mul_f32 v[150:151], v[150:151], v[4:5]
  v_pk_mul_f32 v[152:153], v[152:153], v[4:5]
  v_pk_mul_f32 v[154:155], v[154:155], v[4:5]
  v_cvt_pk_bf16_f32 v60, v148, v149
  v_cvt_pk_bf16_f32 v61, v150, v151
  v_cvt_pk_bf16_f32 v62, v152, v153
  v_cvt_pk_bf16_f32 v63, v154, v155
  buffer_store_dwordx4 v[60:63], v2, s[24:27], s23 offen sc1
  s_add_u32 s36, s23, s37
  s_add_u32 s23, s36, s37
  v_pk_mul_f32 v[236:237], v[236:237], v[6:7]
  v_pk_mul_f32 v[238:239], v[238:239], v[6:7]
  v_pk_mul_f32 v[240:241], v[240:241], v[6:7]
  v_pk_mul_f32 v[242:243], v[242:243], v[6:7]
  v_cvt_pk_bf16_f32 v86, v236, v237
  v_cvt_pk_bf16_f32 v87, v238, v239
  v_cvt_pk_bf16_f32 v88, v240, v241
  v_cvt_pk_bf16_f32 v89, v242, v243
  ds_write_b128 v8, v[86:89] offset:7680
  v_pk_mul_f32 v[244:245], v[244:245], v[6:7]
  v_pk_mul_f32 v[246:247], v[246:247], v[6:7]
  v_cvt_pk_bf16_f32 v94, v244, v245
  v_cvt_pk_bf16_f32 v95, v246, v247
  ds_write_b64 v9, v[94:95] offset:8704
  v_pk_mul_f32 v[248:249], v[248:249], v[6:7]
  v_pk_mul_f32 v[250:251], v[250:251], v[6:7]
  v_pk_mul_f32 v[252:253], v[252:253], v[6:7]
  v_pk_mul_f32 v[254:255], v[254:255], v[6:7]
  v_cvt_pk_bf16_f32 v90, v248, v249
  v_cvt_pk_bf16_f32 v91, v250, v251
  v_cvt_pk_bf16_f32 v92, v252, v253
  v_cvt_pk_bf16_f32 v93, v254, v255
  ds_write_b128 v8, v[90:93] offset:8960
  v_mov_b32 v13, 10
  ds_write_b32 v12, v13
  v_pk_mul_f32 v[156:157], v[156:157], v[4:5]
  v_pk_mul_f32 v[158:159], v[158:159], v[4:5]
  v_pk_mul_f32 v[160:161], v[160:161], v[4:5]
  v_pk_mul_f32 v[162:163], v[162:163], v[4:5]
  v_cvt_pk_bf16_f32 v76, v156, v157
  v_cvt_pk_bf16_f32 v77, v158, v159
  v_cvt_pk_bf16_f32 v78, v160, v161
  v_cvt_pk_bf16_f32 v79, v162, v163
  buffer_store_dwordx4 v[76:79], v2, s[24:27], s36 offen sc1
  v_pk_mul_f32 v[164:165], v[164:165], v[4:5]
  v_pk_mul_f32 v[166:167], v[166:167], v[4:5]
  v_cvt_pk_bf16_f32 v84, v164, v165
  v_cvt_pk_bf16_f32 v85, v166, v167
  buffer_store_dwordx2 v[84:85], v3, s[24:27], s36 offen sc1
  v_pk_mul_f32 v[168:169], v[168:169], v[4:5]
  v_pk_mul_f32 v[170:171], v[170:171], v[4:5]
  v_pk_mul_f32 v[172:173], v[172:173], v[4:5]
  v_pk_mul_f32 v[174:175], v[174:175], v[4:5]
  v_cvt_pk_bf16_f32 v80, v168, v169
  v_cvt_pk_bf16_f32 v81, v170, v171
  v_cvt_pk_bf16_f32 v82, v172, v173
  v_cvt_pk_bf16_f32 v83, v174, v175
  buffer_store_dwordx4 v[80:83], v2, s[24:27], s23 offen sc1
  s_add_u32 s36, s23, s37
  s_branch L1_fin
L1_epi_ffn:
  s_mul_i32 s88, s21, 141312
  s_add_u32 s88, s88, 10571776
  s_sub_u32 s37, s28, 12
  s_mul_i32 s37, s37, 2560
  s_add_u32 s88, s88, s37
  s_add_u32 s89, s88, 141312
  v_pk_mul_f32 v[176:177], v[176:177], v[184:185]
  v_pk_mul_f32 v[178:179], v[178:179], v[186:187]
  v_pk_mul_f32 v[180:181], v[180:181], v[188:189]
  v_pk_mul_f32 v[182:183], v[182:183], v[190:191]
  v_cvt_pk_bf16_f32 v176, v176, v177
  v_cvt_pk_bf16_f32 v177, v178, v179
  v_cvt_pk_bf16_f32 v178, v180, v181
  v_cvt_pk_bf16_f32 v179, v182, v183
  v_pk_mul_f32 v[96:97], v[96:97], v[104:105]
  v_pk_mul_f32 v[98:99], v[98:99], v[106:107]
  v_pk_mul_f32 v[100:101], v[100:101], v[108:109]
  v_pk_mul_f32 v[102:103], v[102:103], v[110:111]
  v_cvt_pk_bf16_f32 v180, v96, v97
  v_cvt_pk_bf16_f32 v181, v98, v99
  v_cvt_pk_bf16_f32 v182, v100, v101
  v_cvt_pk_bf16_f32 v183, v102, v103
  v_pk_mul_f32 v[192:193], v[192:193], v[200:201]
  v_pk_mul_f32 v[194:195], v[194:195], v[202:203]
  v_pk_mul_f32 v[196:197], v[196:197], v[204:205]
  v_pk_mul_f32 v[198:199], v[198:199], v[206:207]
  v_cvt_pk_bf16_f32 v192, v192, v193
  v_cvt_pk_bf16_f32 v193, v194, v195
  v_cvt_pk_bf16_f32 v194, v196, v197
  v_cvt_pk_bf16_f32 v195, v198, v199
  v_pk_mul_f32 v[112:113], v[112:113], v[120:121]
  v_pk_mul_f32 v[114:115], v[114:115], v[122:123]
  v_pk_mul_f32 v[116:117], v[116:117], v[124:125]
  v_pk_mul_f32 v[118:119], v[118:119], v[126:127]
  v_cvt_pk_bf16_f32 v196, v112, v113
  v_cvt_pk_bf16_f32 v197, v114, v115
  v_cvt_pk_bf16_f32 v198, v116, v117
  v_cvt_pk_bf16_f32 v199, v118, v119
  v_pk_mul_f32 v[208:209], v[208:209], v[216:217]
  v_pk_mul_f32 v[210:211], v[210:211], v[218:219]
  v_pk_mul_f32 v[212:213], v[212:213], v[220:221]
  v_pk_mul_f32 v[214:215], v[214:215], v[222:223]
  v_cvt_pk_bf16_f32 v208, v208, v209
  v_cvt_pk_bf16_f32 v209, v210, v211
  v_cvt_pk_bf16_f32 v210, v212, v213
  v_cvt_pk_bf16_f32 v211, v214, v215
  v_pk_mul_f32 v[128:129], v[128:129], v[136:137]
  v_pk_mul_f32 v[130:131], v[130:131], v[138:139]
  v_pk_mul_f32 v[132:133], v[132:133], v[140:141]
  v_pk_mul_f32 v[134:135], v[134:135], v[142:143]
  v_cvt_pk_bf16_f32 v212, v128, v129
  v_cvt_pk_bf16_f32 v213, v130, v131
  v_cvt_pk_bf16_f32 v214, v132, v133
  v_cvt_pk_bf16_f32 v215, v134, v135
  v_pk_mul_f32 v[224:225], v[224:225], v[232:233]
  v_pk_mul_f32 v[226:227], v[226:227], v[234:235]
  v_pk_mul_f32 v[228:229], v[228:229], v[236:237]
  v_pk_mul_f32 v[230:231], v[230:231], v[238:239]
  v_cvt_pk_bf16_f32 v224, v224, v225
  v_cvt_pk_bf16_f32 v225, v226, v227
  v_cvt_pk_bf16_f32 v226, v228, v229
  v_cvt_pk_bf16_f32 v227, v230, v231
  v_pk_mul_f32 v[144:145], v[144:145], v[152:153]
  v_pk_mul_f32 v[146:147], v[146:147], v[154:155]
  v_pk_mul_f32 v[148:149], v[148:149], v[156:157]
  v_pk_mul_f32 v[150:151], v[150:151], v[158:159]
  v_cvt_pk_bf16_f32 v228, v144, v145
  v_cvt_pk_bf16_f32 v229, v146, v147
  v_cvt_pk_bf16_f32 v230, v148, v149
  v_cvt_pk_bf16_f32 v231, v150, v151
  v_pk_mul_f32 v[240:241], v[240:241], v[248:249]
  v_pk_mul_f32 v[242:243], v[242:243], v[250:251]
  v_pk_mul_f32 v[244:245], v[244:245], v[252:253]
  v_pk_mul_f32 v[246:247], v[246:247], v[254:255]
  v_cvt_pk_bf16_f32 v240, v240, v241
  v_cvt_pk_bf16_f32 v241, v242, v243
  v_cvt_pk_bf16_f32 v242, v244, v245
  v_cvt_pk_bf16_f32 v243, v246, v247
  v_pk_mul_f32 v[160:161], v[160:161], v[168:169]
  v_pk_mul_f32 v[162:163], v[162:163], v[170:171]
  v_pk_mul_f32 v[164:165], v[164:165], v[172:173]
  v_pk_mul_f32 v[166:167], v[166:167], v[174:175]
  v_cvt_pk_bf16_f32 v244, v160, v161
  v_cvt_pk_bf16_f32 v245, v162, v163
  v_cvt_pk_bf16_f32 v246, v164, v165
  v_cvt_pk_bf16_f32 v247, v166, v167
  s_cmp_eq_u32 s28, 31
  s_cselect_b32 s91, 2, 1
  s_waitcnt lgkmcnt(0)
  s_branch L1_fin
  .p2align 6
L1_loopB:
  s_cmp_eq_u32 s35, s84
  s_cbranch_scc1 L1_sideB
L1_backB:
  s_waitcnt lgkmcnt(8)
  v_mfma_f32_32x32x16_bf16 v[96:111], v[56:59], v[16:19], v[96:111]
  ds_read_b128 v[64:67], v11
  ds_read_b128 v[68:71], v11 offset:4096
  v_mfma_f32_32x32x16_bf16 v[176:191], v[60:63], v[16:19], v[176:191]
  ds_read_b64_tr_b16 v[36:37], v5 offset:2560
  ds_read_b64_tr_b16 v[38:39], v5 offset:3200
  s_waitcnt lgkmcnt(10)
  v_mfma_f32_32x32x16_bf16 v[112:127], v[56:59], v[20:23], v[112:127]
  ds_read_b64_tr_b16 v[40:41], v6 offset:2560
  ds_read_b64_tr_b16 v[42:43], v6 offset:3200
  v_mfma_f32_32x32x16_bf16 v[192:207], v[60:63], v[20:23], v[192:207]
  ds_read_b64_tr_b16 v[44:45], v7 offset:2560
  ds_read_b64_tr_b16 v[46:47], v7 offset:3200
  s_waitcnt lgkmcnt(12)
  v_mfma_f32_32x32x16_bf16 v[128:143], v[56:59], v[24:27], v[128:143]
  ds_read_b64_tr_b16 v[48:49], v8 offset:2560
  ds_read_b64_tr_b16 v[50:51], v8 offset:3200
  v_mfma_f32_32x32x16_bf16 v[208:223], v[60:63], v[24:27], v[208:223]
  ds_read_b64_tr_b16 v[52:53], v9 offset:2560
  ds_read_b64_tr_b16 v[54:55], v9 offset:3200
  s_waitcnt lgkmcnt(14)
  v_mfma_f32_32x32x16_bf16 v[144:159], v[56:59], v[28:31], v[144:159]
  v_mfma_f32_32x32x16_bf16 v[224:239], v[60:63], v[28:31], v[224:239]
  s_waitcnt lgkmcnt(12)
  v_mfma_f32_32x32x16_bf16 v[160:175], v[56:59], v[32:35], v[160:175]
  v_mfma_f32_32x32x16_bf16 v[240:255], v[60:63], v[32:35], v[240:255]
  s_waitcnt lgkmcnt(8)
  v_mfma_f32_32x32x16_bf16 v[96:111], v[64:67], v[36:39], v[96:111]
  ds_read_b128 v[56:59], v12
  ds_read_b128 v[60:63], v12 offset:4096
  v_mfma_f32_32x32x16_bf16 v[176:191], v[68:71], v[36:39], v[176:191]
  ds_read_b64_tr_b16 v[16:17], v5 offset:5120
  ds_read_b64_tr_b16 v[18:19], v5 offset:5760
  s_waitcnt lgkmcnt(10)
  v_mfma_f32_32x32x16_bf16 v[112:127], v[64:67], v[40:43], v[112:127]
  ds_read_b64_tr_b16 v[20:21], v6 offset:5120
  ds_read_b64_tr_b16 v[22:23], v6 offset:5760
  v_mfma_f32_32x32x16_bf16 v[192:207], v[68:71], v[40:43], v[192:207]
  ds_read_b64_tr_b16 v[24:25], v7 offset:5120
  ds_read_b64_tr_b16 v[26:27], v7 offset:5760
  s_waitcnt lgkmcnt(12)
  v_mfma_f32_32x32x16_bf16 v[128:143], v[64:67], v[44:47], v[128:143]
  ds_read_b64_tr_b16 v[28:29], v8 offset:5120
  ds_read_b64_tr_b16 v[30:31], v8 offset:5760
  v_mfma_f32_32x32x16_bf16 v[208:223], v[68:71], v[44:47], v[208:223]
  ds_read_b64_tr_b16 v[32:33], v9 offset:5120
  ds_read_b64_tr_b16 v[34:35], v9 offset:5760
  s_waitcnt lgkmcnt(14)
  v_mfma_f32_32x32x16_bf16 v[144:159], v[64:67], v[48:51], v[144:159]
  v_mfma_f32_32x32x16_bf16 v[224:239], v[68:71], v[48:51], v[224:239]
  s_waitcnt lgkmcnt(12)
  v_mfma_f32_32x32x16_bf16 v[160:175], v[64:67], v[52:55], v[160:175]
  v_mfma_f32_32x32x16_bf16 v[240:255], v[68:71], v[52:55], v[240:255]
  s_waitcnt lgkmcnt(8)
  v_mfma_f32_32x32x16_bf16 v[96:111], v[56:59], v[16:19], v[96:111]
  ds_read_b128 v[64:67], v13
  ds_read_b128 v[68:71], v13 offset:4096
  v_mfma_f32_32x32x16_bf16 v[176:191], v[60:63], v[16:19], v[176:191]
  ds_read_b64_tr_b16 v[36:37], v5 offset:7680
  ds_read_b64_tr_b16 v[38:39], v5 offset:8320
  s_waitcnt lgkmcnt(10)
  v_mfma_f32_32x32x16_bf16 v[112:127], v[56:59], v[20:23], v[112:127]
  ds_read_b64_tr_b16 v[40:41], v6 offset:7680
  ds_read_b64_tr_b16 v[42:43], v6 offset:8320
  v_mfma_f32_32x32x16_bf16 v[192:207], v[60:63], v[20:23], v[192:207]
  ds_read_b64_tr_b16 v[44:45], v7 offset:7680
  ds_read_b64_tr_b16 v[46:47], v7 offset:8320
  s_waitcnt lgkmcnt(12)
  v_mfma_f32_32x32x16_bf16 v[128:143], v[56:59], v[24:27], v[128:143]
  ds_read_b64_tr_b16 v[48:49], v8 offset:7680
  ds_read_b64_tr_b16 v[50:51], v8 offset:8320
  v_mfma_f32_32x32x16_bf16 v[208:223], v[60:63], v[24:27], v[208:223]
  ds_read_b64_tr_b16 v[52:53], v9 offset:7680
  ds_read_b64_tr_b16 v[54:55], v9 offset:8320
  s_waitcnt lgkmcnt(14)
  v_mfma_f32_32x32x16_bf16 v[144:159], v[56:59], v[28:31], v[144:159]
  v_mfma_f32_32x32x16_bf16 v[224:239], v[60:63], v[28:31], v[224:239]
  s_waitcnt lgkmcnt(12)
  v_mfma_f32_32x32x16_bf16 v[160:175], v[56:59], v[32:35], v[160:175]
  v_add_u32 v10, s32, v10
  v_mfma_f32_32x32x16_bf16 v[240:255], v[60:63], v[32:35], v[240:255]
  s_waitcnt vmcnt(2) lgkmcnt(0)
  v_mfma_f32_32x32x16_bf16 v[96:111], v[64:67], v[36:39], v[96:111]
  s_barrier
  ds_read_b128 v[56:59], v10
  ds_read_b128 v[60:63], v10 offset:4096
  v_mfma_f32_32x32x16_bf16 v[176:191], v[68:71], v[36:39], v[176:191]
  v_add_u32 v5, s32, v5
  ds_read_b64_tr_b16 v[16:17], v5 offset:0
  ds_read_b64_tr_b16 v[18:19], v5 offset:640
  v_mfma_f32_32x32x16_bf16 v[112:127], v[64:67], v[40:43], v[112:127]
  v_add_u32 v6, s32, v6
  ds_read_b64_tr_b16 v[20:21], v6 offset:0
  ds_read_b64_tr_b16 v[22:23], v6 offset:640
  v_mfma_f32_32x32x16_bf16 v[192:207], v[68:71], v[40:43], v[192:207]
  v_add_u32 v7, s32, v7
  ds_read_b64_tr_b16 v[24:25], v7 offset:0
  ds_read_b64_tr_b16 v[26:27], v7 offset:640
  v_mfma_f32_32x32x16_bf16 v[128:143], v[64:67], v[44:47], v[128:143]
  v_add_u32 v8, s32, v8
  ds_read_b64_tr_b16 v[28:29], v8 offset:0
  ds_read_b64_tr_b16 v[30:31], v8 offset:640
  v_mfma_f32_32x32x16_bf16 v[208:223], v[68:71], v[44:47], v[208:223]
  v_add_u32 v9, s32, v9
  ds_read_b64_tr_b16 v[32:33], v9 offset:0
  ds_read_b64_tr_b16 v[34:35], v9 offset:640
  v_mfma_f32_32x32x16_bf16 v[144:159], v[64:67], v[48:51], v[144:159]
  v_mfma_f32_32x32x16_bf16 v[224:239], v[68:71], v[48:51], v[224:239]
  v_add_u32 v11, s32, v11
  v_mfma_f32_32x32x16_bf16 v[160:175], v[64:67], v[52:55], v[160:175]
  v_add_u32 v12, s32, v12
  v_mfma_f32_32x32x16_bf16 v[240:255], v[68:71], v[52:55], v[240:255]
  v_add_u32 v13, s32, v13
  s_add_u32 s33, s33, 1
  s_cmp_eq_u32 s33, 2
  s_mov_b32 s32, 53504
  s_cselect_b32 s32, 4294860288, s32
  s_cmp_eq_u32 s33, 3
  s_cselect_b32 s33, 0, s33
  s_add_u32 s35, s35, 1
  s_cmp_lt_u32 s35, 10
  s_cbranch_scc1 L1_loopB
  s_waitcnt vmcnt(0) lgkmcnt(0)
  v_mfma_f32_32x32x16_bf16 v[96:111], v[56:59], v[16:19], v[96:111]
  s_cmp_lg_u32 s3, 0
  s_cbranch_scc1 L1_nononB
  s_mov_b32 s86, 20000
  v_mov_b32 v15, 0
L1_nwB:
  v_readfirstlane_b32 s87, v14
  s_nop 1
  s_cmp_lg_u32 s87, 0
  s_cbranch_scc1 L1_nokB
  buffer_load_dword v14, v15, s[60:63], 0 offen offset:24 sc1
  s_sub_u32 s86, s86, 1
  s_cmp_gt_i32 s86, 0
  s_waitcnt vmcnt(0)
  s_cbranch_scc1 L1_nwB
L1_nokB:
  v_mov_b32 v14, s87
  v_mov_b32 v15, 163000
  ds_write_b32 v15, v14
L1_nononB:
  v_and_b32 v10, 31, v1
  v_lshrrev_b32 v11, 5, v1
  s_lshl_b32 s38, s3, 8
  s_add_u32 s38, s38, 160512
  s_lshl_b32 s21, s29, 3
  s_lshl_b32 s22, s3, 1
  s_add_u32 s21, s21, s22
  v_lshlrev_b32 v12, 4, v11
  v_add_u32 v12, s38, v12
  v_mov_b32 v5, v72
  v_mov_b32 v52, v91
  v_mov_b32 v6, v73
  v_mov_b32 v53, v92
  v_mov_b32 v7, v74
  v_mov_b32 v54, v93
  v_mov_b32 v8, v75
  v_mov_b32 v55, v94
  v_mov_b32 v9, v76
  v_mov_b32 v4, v95
  ds_read_b128 v[36:39], v12 offset:0
  ds_read_b128 v[40:43], v12 offset:32
  ds_read_b128 v[44:47], v12 offset:64
  ds_read_b128 v[48:51], v12 offset:96
  ds_read_b128 v[76:79], v12 offset:128
  ds_read_b128 v[80:83], v12 offset:160
  ds_read_b128 v[84:87], v12 offset:192
  ds_read_b128 v[88:91], v12 offset:224
  v_mfma_f32_32x32x16_bf16 v[176:191], v[60:63], v[16:19], v[176:191]
  v_mfma_f32_32x32x16_bf16 v[112:127], v[56:59], v[20:23], v[112:127]
  v_mfma_f32_32x32x16_bf16 v[192:207], v[60:63], v[20:23], v[192:207]
  v_mfma_f32_32x32x16_bf16 v[128:143], v[56:59], v[24:27], v[128:143]
  v_mfma_f32_32x32x16_bf16 v[208:223], v[60:63], v[24:27], v[208:223]
  v_mfma_f32_32x32x16_bf16 v[144:159], v[56:59], v[28:31], v[144:159]
  v_mfma_f32_32x32x16_bf16 v[224:239], v[60:63], v[28:31], v[224:239]
  v_mfma_f32_32x32x16_bf16 v[160:175], v[56:59], v[32:35], v[160:175]
  v_mfma_f32_32x32x16_bf16 v[240:255], v[60:63], v[32:35], v[240:255]
  s_sub_u32 s36, s28, 8
  s_mul_i32 s36, s36, 1310720
  s_mul_i32 s37, s21, 2560
  s_add_u32 s36, s36, s37
  s_add_u32 s36, s36, 5244160
  s_lshl_b32 s22, s3, 2
  s_add_u32 s22, s22, 161536
  v_mov_b32 v12, s22
  s_waitcnt lgkmcnt(0)
  v_pk_mul_f32 v[176:177], v[176:177], v[76:77]
  v_pk_mul_f32 v[178:179], v[178:179], v[78:79]
  v_pk_mul_f32 v[180:181], v[180:181], v[80:81]
  v_pk_mul_f32 v[182:183], v[182:183], v[82:83]
  v_pk_mul_f32 v[184:185], v[184:185], v[84:85]
  v_pk_mul_f32 v[186:187], v[186:187], v[86:87]
  v_pk_mul_f32 v[188:189], v[188:189], v[88:89]
  v_pk_mul_f32 v[190:191], v[190:191], v[90:91]
  v_cvt_pk_bf16_f32 v24, v176, v177
  v_cvt_pk_bf16_f32 v25, v178, v179
  v_cvt_pk_bf16_f32 v26, v180, v181
  v_cvt_pk_bf16_f32 v27, v182, v183
  v_cvt_pk_bf16_f32 v28, v184, v185
  v_cvt_pk_bf16_f32 v29, v186, v187
  v_cvt_pk_bf16_f32 v30, v188, v189
  v_cvt_pk_bf16_f32 v31, v190, v191
  ds_write_b128 v52, v[24:27]
  ds_write_b128 v52, v[28:31] offset:640
  v_mov_b32 v13, 1
  ds_write_b32 v12, v13
  v_pk_mul_f32 v[96:97], v[96:97], v[36:37]
  v_pk_mul_f32 v[98:99], v[98:99], v[38:39]
  v_pk_mul_f32 v[100:101], v[100:101], v[40:41]
  v_pk_mul_f32 v[102:103], v[102:103], v[42:43]
  v_pk_mul_f32 v[104:105], v[104:105], v[44:45]
  v_pk_mul_f32 v[106:107], v[106:107], v[46:47]
  v_pk_mul_f32 v[108:109], v[108:109], v[48:49]
  v_pk_mul_f32 v[110:111], v[110:111], v[50:51]
  v_cvt_pk_bf16_f32 v16, v96, v97
  v_cvt_pk_bf16_f32 v17, v98, v99
  v_cvt_pk_bf16_f32 v18, v100, v101
  v_cvt_pk_bf16_f32 v19, v102, v103
  v_cvt_pk_bf16_f32 v20, v104, v105
  v_cvt_pk_bf16_f32 v21, v106, v107
  v_cvt_pk_bf16_f32 v22, v108, v109
  v_cvt_pk_bf16_f32 v23, v110, v111
  buffer_store_dwordx4 v[16:19], v5, s[24:27], s36 offen sc1
  buffer_store_dwordx4 v[20:23], v5, s[24:27], s36 offen offset:640 sc1
  v_pk_mul_f32 v[192:193], v[192:193], v[76:77]
  v_pk_mul_f32 v[194:195], v[194:195], v[78:79]
  v_pk_mul_f32 v[196:197], v[196:197], v[80:81]
  v_pk_mul_f32 v[198:199], v[198:199], v[82:83]
  v_pk_mul_f32 v[200:201], v[200:201], v[84:85]
  v_pk_mul_f32 v[202:203], v[202:203], v[86:87]
  v_pk_mul_f32 v[204:205], v[204:205], v[88:89]
  v_pk_mul_f32 v[206:207], v[206:207], v[90:91]
  v_cvt_pk_bf16_f32 v64, v192, v193
  v_cvt_pk_bf16_f32 v65, v194, v195
  v_cvt_pk_bf16_f32 v66, v196, v197
  v_cvt_pk_bf16_f32 v67, v198, v199
  v_cvt_pk_bf16_f32 v68, v200, v201
  v_cvt_pk_bf16_f32 v69, v202, v203
  v_cvt_pk_bf16_f32 v70, v204, v205
  v_cvt_pk_bf16_f32 v71, v206, v207
  ds_write_b128 v53, v[64:67]
  ds_write_b128 v53, v[68:71] offset:640
  v_mov_b32 v13, 3
  ds_write_b32 v12, v13
  v_pk_mul_f32 v[112:113], v[112:113], v[36:37]
  v_pk_mul_f32 v[114:115], v[114:115], v[38:39]
  v_pk_mul_f32 v[116:117], v[116:117], v[40:41]
  v_pk_mul_f32 v[118:119], v[118:119], v[42:43]
  v_pk_mul_f32 v[120:121], v[120:121], v[44:45]
  v_pk_mul_f32 v[122:123], v[122:123], v[46:47]
  v_pk_mul_f32 v[124:125], v[124:125], v[48:49]
  v_pk_mul_f32 v[126:127], v[126:127], v[50:51]
  v_cvt_pk_bf16_f32 v56, v112, v113
  v_cvt_pk_bf16_f32 v57, v114, v115
  v_cvt_pk_bf16_f32 v58, v116, v117
  v_cvt_pk_bf16_f32 v59, v118, v119
  v_cvt_pk_bf16_f32 v60, v120, v121
  v_cvt_pk_bf16_f32 v61, v122, v123
  v_cvt_pk_bf16_f32 v62, v124, v125
  v_cvt_pk_bf16_f32 v63, v126, v127
  buffer_store_dwordx4 v[56:59], v6, s[24:27], s36 offen sc1
  buffer_store_dwordx4 v[60:63], v6, s[24:27], s36 offen offset:640 sc1
  v_pk_mul_f32 v[208:209], v[208:209], v[76:77]
  v_pk_mul_f32 v[210:211], v[210:211], v[78:79]
  v_pk_mul_f32 v[212:213], v[212:213], v[80:81]
  v_pk_mul_f32 v[214:215], v[214:215], v[82:83]
  v_pk_mul_f32 v[216:217], v[216:217], v[84:85]
  v_pk_mul_f32 v[218:219], v[218:219], v[86:87]
  v_pk_mul_f32 v[220:221], v[220:221], v[88:89]
  v_pk_mul_f32 v[222:223], v[222:223], v[90:91]
  v_cvt_pk_bf16_f32 v24, v208, v209
  v_cvt_pk_bf16_f32 v25, v210, v211
  v_cvt_pk_bf16_f32 v26, v212, v213
  v_cvt_pk_bf16_f32 v27, v214, v215
  v_cvt_pk_bf16_f32 v28, v216, v217
  v_cvt_pk_bf16_f32 v29, v218, v219
  v_cvt_pk_bf16_f32 v30, v220, v221
  v_cvt_pk_bf16_f32 v31, v222, v223
  ds_write_b128 v54, v[24:27]
  ds_write_b128 v54, v[28:31] offset:640
  v_mov_b32 v13, 5
  ds_write_b32 v12, v13
  v_pk_mul_f32 v[128:129], v[128:129], v[36:37]
  v_pk_mul_f32 v[130:131], v[130:131], v[38:39]
  v_pk_mul_f32 v[132:133], v[132:133], v[40:41]
  v_pk_mul_f32 v[134:135], v[134:135], v[42:43]
  v_pk_mul_f32 v[136:137], v[136:137], v[44:45]
  v_pk_mul_f32 v[138:139], v[138:139], v[46:47]
  v_pk_mul_f32 v[140:141], v[140:141], v[48:49]
  v_pk_mul_f32 v[142:143], v[142:143], v[50:51]
  v_cvt_pk_bf16_f32 v16, v128, v129
  v_cvt_pk_bf16_f32 v17, v130, v131
  v_cvt_pk_bf16_f32 v18, v132, v133
  v_cvt_pk_bf16_f32 v19, v134, v135
  v_cvt_pk_bf16_f32 v20, v136, v137
  v_cvt_pk_bf16_f32 v21, v138, v139
  v_cvt_pk_bf16_f32 v22, v140, v141
  v_cvt_pk_bf16_f32 v23, v142, v143
  buffer_store_dwordx4 v[16:19], v7, s[24:27], s36 offen sc1
  buffer_store_dwordx4 v[20:23], v7, s[24:27], s36 offen offset:640 sc1
  v_pk_mul_f32 v[224:225], v[224:225], v[76:77]
  v_pk_mul_f32 v[226:227], v[226:227], v[78:79]
  v_pk_mul_f32 v[228:229], v[228:229], v[80:81]
  v_pk_mul_f32 v[230:231], v[230:231], v[82:83]
  v_pk_mul_f32 v[232:233], v[232:233], v[84:85]
  v_pk_mul_f32 v[234:235], v[234:235], v[86:87]
  v_pk_mul_f32 v[236:237], v[236:237], v[88:89]
  v_pk_mul_f32 v[238:239], v[238:239], v[90:91]
  v_cvt_pk_bf16_f32 v64, v224, v225
  v_cvt_pk_bf16_f32 v65, v226, v227
  v_cvt_pk_bf16_f32 v66, v228, v229
  v_cvt_pk_bf16_f32 v67, v230, v231
  v_cvt_pk_bf16_f32 v68, v232, v233
  v_cvt_pk_bf16_f32 v69, v234, v235
  v_cvt_pk_bf16_f32 v70, v236, v237
  v_cvt_pk_bf16_f32 v71, v238, v239
  ds_write_b128 v55, v[64:67]
  ds_write_b128 v55, v[68:71] offset:640
  v_mov_b32 v13, 7
  ds_write_b32 v12, v13
  v_pk_mul_f32 v[144:145], v[144:145], v[36:37]
  v_pk_mul_f32 v[146:147], v[146:147], v[38:39]
  v_pk_mul_f32 v[148:149], v[148:149], v[40:41]
  v_pk_mul_f32 v[150:151], v[150:151], v[42:43]
  v_pk_mul_f32 v[152:153], v[152:153], v[44:45]
  v_pk_mul_f32 v[154:155], v[154:155], v[46:47]
  v_pk_mul_f32 v[156:157], v[156:157], v[48:49]
  v_pk_mul_f32 v[158:159], v[158:159], v[50:51]
  v_cvt_pk_bf16_f32 v56, v144, v145
  v_cvt_pk_bf16_f32 v57, v146, v147
  v_cvt_pk_bf16_f32 v58, v148, v149
  v_cvt_pk_bf16_f32 v59, v150, v151
  v_cvt_pk_bf16_f32 v60, v152, v153
  v_cvt_pk_bf16_f32 v61, v154, v155
  v_cvt_pk_bf16_f32 v62, v156, v157
  v_cvt_pk_bf16_f32 v63, v158, v159
  buffer_store_dwordx4 v[56:59], v8, s[24:27], s36 offen sc1
  buffer_store_dwordx4 v[60:63], v8, s[24:27], s36 offen offset:640 sc1
  v_pk_mul_f32 v[240:241], v[240:241], v[76:77]
  v_pk_mul_f32 v[242:243], v[242:243], v[78:79]
  v_pk_mul_f32 v[244:245], v[244:245], v[80:81]
  v_pk_mul_f32 v[246:247], v[246:247], v[82:83]
  v_pk_mul_f32 v[248:249], v[248:249], v[84:85]
  v_pk_mul_f32 v[250:251], v[250:251], v[86:87]
  v_pk_mul_f32 v[252:253], v[252:253], v[88:89]
  v_pk_mul_f32 v[254:255], v[254:255], v[90:91]
  v_cvt_pk_bf16_f32 v24, v240, v241
  v_cvt_pk_bf16_f32 v25, v242, v243
  v_cvt_pk_bf16_f32 v26, v244, v245
  v_cvt_pk_bf16_f32 v27, v246, v247
  v_cvt_pk_bf16_f32 v28, v248, v249
  v_cvt_pk_bf16_f32 v29, v250, v251
  v_cvt_pk_bf16_f32 v30, v252, v253
  v_cvt_pk_bf16_f32 v31, v254, v255
  ds_write_b128 v4, v[24:27]
  ds_write_b128 v4, v[28:31] offset:640
  v_mov_b32 v13, 10
  ds_write_b32 v12, v13
  v_pk_mul_f32 v[160:161], v[160:161], v[36:37]
  v_pk_mul_f32 v[162:163], v[162:163], v[38:39]
  v_pk_mul_f32 v[164:165], v[164:165], v[40:41]
  v_pk_mul_f32 v[166:167], v[166:167], v[42:43]
  v_pk_mul_f32 v[168:169], v[168:169], v[44:45]
  v_pk_mul_f32 v[170:171], v[170:171], v[46:47]
  v_pk_mul_f32 v[172:173], v[172:173], v[48:49]
  v_pk_mul_f32 v[174:175], v[174:175], v[50:51]
  v_cvt_pk_bf16_f32 v16, v160, v161
  v_cvt_pk_bf16_f32 v17, v162, v163
  v_cvt_pk_bf16_f32 v18, v164, v165
  v_cvt_pk_bf16_f32 v19, v166, v167
  v_cvt_pk_bf16_f32 v20, v168, v169
  v_cvt_pk_bf16_f32 v21, v170, v171
  v_cvt_pk_bf16_f32 v22, v172, v173
  v_cvt_pk_bf16_f32 v23, v174, v175
  buffer_store_dwordx4 v[16:19], v9, s[24:27], s36 offen sc1
  buffer_store_dwordx4 v[20:23], v9, s[24:27], s36 offen offset:640 sc1
  s_branch L1_fin
L1_sideA:
  s_cmp_lg_u32 s84, 5
  s_cbranch_scc1 L1_side1A
  buffer_load_dword v4, v3, s[56:59], s85 offen
  s_mov_b32 s84, s83
  s_branch L1_backA
L1_side1A:
  v_mov_b32 v15, 0
  s_mov_b64 exec, 1
  s_cmp_lg_u32 s84, 1
  s_cbranch_scc1 L1_side2A
  s_lshl_b32 s36, s29, 5
  s_memrealtime s[86:87]
  v_mov_b32 v77, 1
  buffer_atomic_add v77, v15, s[60:63], s36 offen sc1
  s_cmp_eq_u32 s2, 0
  s_cselect_b32 s36, 24, 0x40000000
  s_waitcnt lgkmcnt(0)
  s_or_b32 s86, s86, 1
  v_mov_b32 v14, s86
  buffer_store_dword v14, v15, s[60:63], s36 offen sc1
  s_mov_b32 s84, 5
  s_mov_b64 exec, -1
  s_branch L1_backA
L1_side2A:
  buffer_load_dword v14, v15, s[60:63], 0 offen offset:24 sc1
  s_mov_b64 exec, -1
  s_branch L1_backA
L1_sideB:
  s_cmp_lg_u32 s84, 5
  s_cbranch_scc1 L1_side1B
  buffer_load_dword v4, v3, s[56:59], s85 offen
  s_mov_b32 s84, s83
  s_branch L1_backB
L1_side1B:
  v_mov_b32 v15, 0
  s_mov_b64 exec, 1
  s_cmp_lg_u32 s84, 1
  s_cbranch_scc1 L1_side2B
  s_lshl_b32 s36, s29, 5
  s_memrealtime s[86:87]
  v_mov_b32 v77, 1
  buffer_atomic_add v77, v15, s[60:63], s36 offen sc1
  s_cmp_eq_u32 s2, 0
  s_cselect_b32 s36, 24, 0x40000000
  s_waitcnt lgkmcnt(0)
  s_or_b32 s86, s86, 1
  v_mov_b32 v14, s86
  buffer_store_dword v14, v15, s[60:63], s36 offen sc1
  s_mov_b32 s84, 5
  s_mov_b64 exec, -1
  s_branch L1_backB
L1_side2B:
  buffer_load_dword v14, v15, s[60:63], 0 offen offset:24 sc1
  s_mov_b64 exec, -1
  s_branch L1_backB
L1_fin:
  v_mov_b32 v4, 163000
  s_mov_b64 s[6:7], s[94:95]
  s_mov_b64 s[48:49], s[4:5]
  s_mov_b64 s[16:17], s[96:97]
  s_mov_b64 s[20:21], s[76:77]
  s_mov_b64 s[22:23], s[78:79]
  s_setprio 0
  s_waitcnt vmcnt(0) lgkmcnt(0)
  s_barrier
  ds_read_b32 v5, v4
  s_waitcnt lgkmcnt(0)
  v_readfirstlane_b32 s90, v5
  s_cmp_lg_u32 s3, 4
  s_cbranch_scc1 LT_w
  s_cmp_ge_u32 s28, 12
  s_cbranch_scc1 LT_nosig
  s_lshl_b32 s36, s2, 7
  s_add_u32 s36, s36, 131072
  v_mov_b32 v5, s90
  v_mov_b32 v4, 0
  s_mov_b64 exec, 1
  buffer_store_dword v5, v4, s[24:27], s36 offen sc1
  s_mov_b64 exec, -1
LT_nosig:
  s_bfe_u32 s36, s2, 0x20001
  s_lshl_b32 s36, s36, 1
  s_lshr_b32 s37, s2, 5
  v_and_b32 v4, 7, v1
  v_lshrrev_b32 v5, 3, v1
  v_cmp_lt_u32 vcc, 1, v5
  v_mov_b32 v6, s37
  s_nop 0
  v_cndmask_b32 v4, v4, v6, vcc
  v_add_u32 v5, 1, v5
  v_cndmask_b32 v5, v5, 0, vcc
  v_lshrrev_b32 v6, 2, v4
  v_and_b32 v4, 3, v4
  v_lshl_add_u32 v6, v4, 3, v6
  v_lshl_add_u32 v6, v5, 5, v6
  v_add_u32 v6, s36, v6
  v_lshlrev_b32 v6, 7, v6
  s_mov_b32 s36, 131072
  s_mov_b32 s37, 20000
LT_poll:
  buffer_load_dword v5, v6, s[24:27], s36 offen sc1
  s_waitcnt vmcnt(0)
  v_cmp_ne_u32 vcc, s90, v5
  s_nop 4
  s_cbranch_vccz LT_w
  s_sub_u32 s37, s37, 1
  s_cmp_le_i32 s37, 0
  s_cbranch_scc1 LT_w
  s_sleep 1
  s_branch LT_poll
LT_w:
  s_and_b32 s36, s2, 7
  s_lshl_b32 s36, s36, 2
  s_bfe_u32 s37, s2, 0x20003
  s_add_u32 s28, s36, s37
  s_lshr_b32 s29, s2, 5
  v_lshlrev_b32 v15, 4, v1
  v_and_b32 v5, 31, v1
  v_lshrrev_b32 v6, 5, v1
  s_and_b32 s36, s3, 3
  s_lshr_b32 s40, s3, 2
  s_mul_i32 s41, s40, 71680
  s_cmp_eq_u32 s40, 0
  s_cselect_b32 s63, 7, 9
  s_mov_b32 s52, 70
  s_cselect_b32 s52, s52, 999
  s_sub_u32 s52, s52, s36
  s_lshl_b32 s42, s36, 10
  s_add_u32 s42, s42, s41
  s_mul_i32 s43, s28, 163840
  s_add_u32 s43, s43, s42
  s_lshl_b32 s37, s36, 1
  s_lshl_b32 s38, s29, 3
  s_add_u32 s35, s37, s38
  s_lshl_b32 s38, s28, 6
  s_add_u32 s38, s38, s35
  s_mul_i32 s38, s38, 1280
  v_lshlrev_b32 v7, 3, v5
  v_add_u32 v7, 1024, v7
  v_lshlrev_b32 v8, 30, v6
  v_add_u32 v8, v8, v7
  s_mov_b32 m0, s42
  s_add_u32 s12, s6, 5242880
  s_addc_u32 s13, s7, 0
  s_mov_b32 s14, 5242880
  s_mov_b32 s15, 0x00020000
  s_add_u32 s8, s6, 2621440
  s_addc_u32 s9, s7, 0
  s_mov_b32 s10, 2621440
  s_mov_b32 s11, 0x00020000
  s_barrier
  s_add_u32 s42, s42, 4096
  buffer_load_dwordx4 v15, s[12:15], s43 offen sc1 lds
  s_add_u32 s43, s43, 4096
  buffer_load_dwordx4 v[16:19], v15, s[8:11], s38 offen offset:0 sc1
  buffer_load_dwordx2 v[20:21], v8, s[8:11], s38 offen offset:0 sc1
  buffer_load_dwordx4 v[24:27], v15, s[8:11], s38 offen offset:1280 sc1
  buffer_load_dwordx2 v[28:29], v8, s[8:11], s38 offen offset:1280 sc1
  s_lshl_b32 s37, s35, 7
  s_add_u32 s37, s37, 8192
  v_lshlrev_b32 v9, 2, v5
  buffer_load_dword v13, v9, s[24:27], s37 offen sc1
  buffer_load_dword v14, v9, s[24:27], s37 offen offset:128 sc1
  s_mov_b32 m0, s42
  s_add_u32 s42, s42, 4096
  buffer_load_dwordx4 v15, s[12:15], s43 offen sc1 lds
  s_add_u32 s43, s43, 4096
  s_mov_b32 m0, s42
  s_add_u32 s42, s42, 4096
  buffer_load_dwordx4 v15, s[12:15], s43 offen sc1 lds
  s_add_u32 s43, s43, 4096
  s_mov_b32 m0, s42
  s_add_u32 s42, s42, 4096
  buffer_load_dwordx4 v15, s[12:15], s43 offen sc1 lds
  s_add_u32 s43, s43, 4096
  v_add_u32 v3, s41, v7
  v_lshl_add_u32 v3, v6, 20, v3
  v_mul_u32_u24 v7, 320, v6
  v_lshl_add_u32 v7, v5, 4, v7
  v_add_u32 v4, 1280, v7
  v_add_u32 v4, s41, v4
  v_add_u32 v2, s41, v15
  s_mov_b32 s30, 0x000fffff
  s_mov_b32 s31, 0x000fffff
  s_mov_b32 s32, 0
  s_mov_b32 s33, -1
  s_mov_b32 s44, 0x01100000
  s_mov_b32 s45, 0x01100000
  v_mov_b32 v9, 0x3f803f80
  v_cndmask_b32 v40, 0, v9, s[44:45]
  v_cndmask_b32 v41, 0, v9, s[44:45]
  v_cndmask_b32 v42, 0, v9, s[44:45]
  v_cndmask_b32 v43, 0, v9, s[44:45]
  v_cndmask_b32 v44, 0, v9, s[44:45]
  v_cndmask_b32 v45, 0, v9, s[44:45]
  v_cndmask_b32 v46, 0, v9, s[44:45]
  v_cndmask_b32 v47, 0, v9, s[44:45]
  v_mov_b64 v[96:97], 0
  v_mov_b64 v[98:99], 0
  v_mov_b64 v[100:101], 0
  v_mov_b64 v[102:103], 0
  v_mov_b64 v[104:105], 0
  v_mov_b64 v[106:107], 0
  v_mov_b64 v[108:109], 0
  v_mov_b64 v[110:111], 0
  v_mov_b64 v[112:113], 0
  v_mov_b64 v[114:115], 0
  v_mov_b64 v[116:117], 0
  v_mov_b64 v[118:119], 0
  v_mov_b64 v[120:121], 0
  v_mov_b64 v[122:123], 0
  v_mov_b64 v[124:125], 0
  v_mov_b64 v[126:127], 0
  v_mov_b64 v[56:57], 0
  v_mov_b64 v[58:59], 0
  v_mov_b64 v[60:61], 0
  v_mov_b64 v[62:63], 0
  s_mov_b32 s46, 0
  s_bfe_u32 s38, s2, 0x20001
  s_lshl_b32 s38, s38, 3
  s_bfe_u32 s39, s2, 0x30003
  s_add_u32 s4, s38, s39
  s_and_b32 s38, s2, 1
  s_lshl_b32 s38, s38, 2
  s_lshr_b32 s39, s2, 6
  s_add_u32 s5, s38, s39
  s_setprio 1
  s_cmp_ge_u32 s3, 4
  s_cbranch_scc1 L2_noprio
  s_setprio 2
L2_noprio:
  s_waitcnt vmcnt(1)
  s_barrier
  ds_read_b128 v[32:35], v2
  ds_read_b64 v[36:37], v3
  s_mov_b32 s34, 0
  s_waitcnt lgkmcnt(0)
  v_mfma_f32_32x32x16_bf16 v[64:79], v[32:35], v[16:19], 0
  v_mfma_f32_32x32x8_bf16 v[64:79], v[36:37], v[20:21], v[64:79]
  v_mfma_f32_32x32x16_bf16 v[80:95], v[32:35], v[24:27], 0
  v_mfma_f32_32x32x8_bf16 v[80:95], v[36:37], v[28:29], v[80:95]
  s_nop 9
  v_max3_f32 v9, v64, v65, v66
  v_max3_f32 v10, v67, v68, v69
  v_max3_f32 v9, v70, v71, v9
  v_max3_f32 v10, v72, v73, v10
  v_max3_f32 v9, v74, v75, v9
  v_max3_f32 v10, v76, v77, v10
  v_max3_f32 v9, v78, v79, v9
  v_max_f32 v9, v9, v10
  v_mov_b32 v10, v9
  s_nop 1
  v_permlane32_swap_b32 v9, v10
  v_max_f32 v9, v9, v10
  v_sub_f32 v128, 0, v9
  v_sub_f32 v129, 0, v9
  v_pk_add_f32 v[64:65], v[64:65], v[128:129]
  v_pk_add_f32 v[66:67], v[66:67], v[128:129]
  v_pk_add_f32 v[68:69], v[68:69], v[128:129]
  v_pk_add_f32 v[70:71], v[70:71], v[128:129]
  v_pk_add_f32 v[72:73], v[72:73], v[128:129]
  v_pk_add_f32 v[74:75], v[74:75], v[128:129]
  v_pk_add_f32 v[76:77], v[76:77], v[128:129]
  v_pk_add_f32 v[78:79], v[78:79], v[128:129]
  v_mov_b64 v[130:131], v[128:129]
  v_mov_b64 v[132:133], v[128:129]
  v_mov_b64 v[134:135], v[128:129]
  v_mov_b64 v[136:137], v[128:129]
  v_mov_b64 v[138:139], v[128:129]
  v_mov_b64 v[140:141], v[128:129]
  v_mov_b64 v[142:143], v[128:129]
  v_max3_f32 v9, v80, v81, v82
  v_max3_f32 v10, v83, v84, v85
  v_max3_f32 v9, v86, v87, v9
  v_max3_f32 v10, v88, v89, v10
  v_max3_f32 v9, v90, v91, v9
  v_max3_f32 v10, v92, v93, v10
  v_max3_f32 v9, v94, v95, v9
  v_max_f32 v9, v9, v10
  v_mov_b32 v10, v9
  s_nop 1
  v_permlane32_swap_b32 v9, v10
  v_max_f32 v9, v9, v10
  v_sub_f32 v144, 0, v9
  v_sub_f32 v145, 0, v9
  v_mov_b64 v[146:147], v[144:145]
  v_mov_b64 v[148:149], v[144:145]
  v_mov_b64 v[150:151], v[144:145]
  v_mov_b64 v[152:153], v[144:145]
  v_mov_b64 v[154:155], v[144:145]
  v_mov_b64 v[156:157], v[144:145]
  v_mov_b64 v[158:159], v[144:145]
  .p2align 6
L2_loopA:
  s_nop 1
  v_mfma_f32_32x32x16_bf16 v[80:95], v[32:35], v[24:27], v[144:159]
  v_exp_f32 v64, v64
  v_exp_f32 v65, v65
  v_exp_f32 v66, v66
  v_exp_f32 v67, v67
  v_cvt_pk_bf16_f32 v48, v64, v65
  v_mfma_f32_32x32x8_bf16 v[80:95], v[36:37], v[28:29], v[80:95]
  ds_read_b128 v[32:35], v2 offset:2560
  ds_read_b64 v[36:37], v3 offset:2560
  v_exp_f32 v68, v68
  v_exp_f32 v69, v69
  v_cvt_pk_bf16_f32 v49, v66, v67
  s_mov_b32 m0, s42
  s_add_u32 s42, s42, 4096
  buffer_load_dwordx4 v15, s[12:15], s43 offen sc1 lds
  s_add_u32 s43, s43, 4096
  v_exp_f32 v70, v70
  v_exp_f32 v71, v71
  v_cvt_pk_bf16_f32 v50, v68, v69
  v_mfma_f32_32x32x16_bf16 v[112:127], v[40:43], v[56:59], v[112:127]
  v_exp_f32 v72, v72
  v_exp_f32 v73, v73
  v_cvt_pk_bf16_f32 v51, v70, v71
  v_exp_f32 v74, v74
  v_exp_f32 v75, v75
  v_cvt_pk_bf16_f32 v52, v72, v73
  v_mfma_f32_32x32x16_bf16 v[112:127], v[44:47], v[60:63], v[112:127]
  s_mov_b64 exec, s[30:31]
  ds_read_b128 v[40:43], v4 offset:0
  ds_read_b128 v[44:47], v4 offset:640
  s_mov_b64 exec, -1
  v_exp_f32 v76, v76
  v_exp_f32 v77, v77
  v_cvt_pk_bf16_f32 v53, v74, v75
  s_mov_b32 m0, s42
  s_add_u32 s42, s42, 4096
  buffer_load_dwordx4 v15, s[12:15], s43 offen sc1 lds
  s_add_u32 s43, s43, 4096
  v_exp_f32 v78, v78
  v_exp_f32 v79, v79
  v_cvt_pk_bf16_f32 v54, v76, v77
  v_cvt_pk_bf16_f32 v55, v78, v79
  s_waitcnt lgkmcnt(2)
  v_mfma_f32_32x32x16_bf16 v[64:79], v[32:35], v[16:19], v[128:143]
  v_exp_f32 v80, v80
  v_exp_f32 v81, v81
  v_exp_f32 v82, v82
  v_exp_f32 v83, v83
  v_cvt_pk_bf16_f32 v56, v80, v81
  v_mfma_f32_32x32x8_bf16 v[64:79], v[36:37], v[20:21], v[64:79]
  v_exp_f32 v84, v84
  v_exp_f32 v85, v85
  v_cvt_pk_bf16_f32 v57, v82, v83
  s_mov_b32 m0, s42
  s_add_u32 s42, s42, 4096
  buffer_load_dwordx4 v15, s[12:15], s43 offen sc1 lds
  s_add_u32 s43, s43, 4096
  v_exp_f32 v86, v86
  v_exp_f32 v87, v87
  v_cvt_pk_bf16_f32 v58, v84, v85
  s_waitcnt lgkmcnt(0)
  v_mfma_f32_32x32x16_bf16 v[96:111], v[40:43], v[48:51], v[96:111]
  v_exp_f32 v88, v88
  v_exp_f32 v89, v89
  v_cvt_pk_bf16_f32 v59, v86, v87
  v_exp_f32 v90, v90
  v_exp_f32 v91, v91
  v_cvt_pk_bf16_f32 v60, v88, v89
  v_mfma_f32_32x32x16_bf16 v[96:111], v[44:47], v[52:55], v[96:111]
  v_exp_f32 v92, v92
  v_exp_f32 v93, v93
  v_cvt_pk_bf16_f32 v61, v90, v91
  s_mov_b32 m0, s42
  s_add_u32 s42, s42, 4096
  buffer_load_dwordx4 v15, s[12:15], s43 offen sc1 lds
  s_add_u32 s43, s43, 4096
  v_exp_f32 v94, v94
  v_exp_f32 v95, v95
  v_cvt_pk_bf16_f32 v62, v92, v93
  v_cvt_pk_bf16_f32 v63, v94, v95
  v_mfma_f32_32x32x16_bf16 v[80:95], v[32:35], v[24:27], v[144:159]
  v_exp_f32 v64, v64
  v_exp_f32 v65, v65
  v_exp_f32 v66, v66
  v_exp_f32 v67, v67
  v_cvt_pk_bf16_f32 v48, v64, v65
  v_mfma_f32_32x32x8_bf16 v[80:95], v[36:37], v[28:29], v[80:95]
  ds_read_b128 v[32:35], v2 offset:5120
  ds_read_b64 v[36:37], v3 offset:5120
  v_exp_f32 v68, v68
  v_exp_f32 v69, v69
  v_cvt_pk_bf16_f32 v49, v66, v67
  s_mov_b32 m0, s42
  s_add_u32 s42, s42, 4096
  buffer_load_dwordx4 v15, s[12:15], s43 offen sc1 lds
  s_add_u32 s43, s43, 4096
  v_exp_f32 v70, v70
  v_exp_f32 v71, v71
  v_cvt_pk_bf16_f32 v50, v68, v69
  v_mfma_f32_32x32x16_bf16 v[112:127], v[40:43], v[56:59], v[112:127]
  v_exp_f32 v72, v72
  v_exp_f32 v73, v73
  v_cvt_pk_bf16_f32 v51, v70, v71
  v_exp_f32 v74, v74
  v_exp_f32 v75, v75
  v_cvt_pk_bf16_f32 v52, v72, v73
  v_mfma_f32_32x32x16_bf16 v[112:127], v[44:47], v[60:63], v[112:127]
  s_mov_b64 exec, s[30:31]
  ds_read_b128 v[40:43], v4 offset:2560
  ds_read_b128 v[44:47], v4 offset:3200
  s_mov_b64 exec, -1
  v_exp_f32 v76, v76
  v_exp_f32 v77, v77
  v_cvt_pk_bf16_f32 v53, v74, v75
  s_mov_b32 m0, s42
  s_add_u32 s42, s42, 4096
  buffer_load_dwordx4 v15, s[12:15], s43 offen sc1 lds
  s_add_u32 s43, s43, 4096
  v_exp_f32 v78, v78
  v_exp_f32 v79, v79
  v_cvt_pk_bf16_f32 v54, v76, v77
  v_cvt_pk_bf16_f32 v55, v78, v79
  s_waitcnt lgkmcnt(2)
  v_mfma_f32_32x32x16_bf16 v[64:79], v[32:35], v[16:19], v[128:143]
  v_exp_f32 v80, v80
  v_exp_f32 v81, v81
  v_exp_f32 v82, v82
  v_exp_f32 v83, v83
  v_cvt_pk_bf16_f32 v56, v80, v81
  v_mfma_f32_32x32x8_bf16 v[64:79], v[36:37], v[20:21], v[64:79]
  v_exp_f32 v84, v84
  v_exp_f32 v85, v85
  v_cvt_pk_bf16_f32 v57, v82, v83
  s_mov_b32 m0, s42
  s_add_u32 s42, s42, 4096
  buffer_load_dwordx4 v15, s[12:15], s43 offen sc1 lds
  s_add_u32 s43, s43, 4096
  v_exp_f32 v86, v86
  v_exp_f32 v87, v87
  v_cvt_pk_bf16_f32 v58, v84, v85
  s_waitcnt lgkmcnt(0)
  v_mfma_f32_32x32x16_bf16 v[96:111], v[40:43], v[48:51], v[96:111]
  v_exp_f32 v88, v88
  v_exp_f32 v89, v89
  v_cvt_pk_bf16_f32 v59, v86, v87
  v_exp_f32 v90, v90
  v_exp_f32 v91, v91
  v_cvt_pk_bf16_f32 v60, v88, v89
  v_mfma_f32_32x32x16_bf16 v[96:111], v[44:47], v[52:55], v[96:111]
  v_exp_f32 v92, v92
  v_exp_f32 v93, v93
  v_cvt_pk_bf16_f32 v61, v90, v91
  s_mov_b32 m0, s42
  s_add_u32 s42, s42, 4096
  buffer_load_dwordx4 v15, s[12:15], s43 offen sc1 lds
  s_add_u32 s43, s43, 4096
  v_exp_f32 v94, v94
  v_exp_f32 v95, v95
  v_cvt_pk_bf16_f32 v62, v92, v93
  v_cvt_pk_bf16_f32 v63, v94, v95
  v_mfma_f32_32x32x16_bf16 v[80:95], v[32:35], v[24:27], v[144:159]
  v_exp_f32 v64, v64
  v_exp_f32 v65, v65
  v_exp_f32 v66, v66
  v_exp_f32 v67, v67
  v_cvt_pk_bf16_f32 v48, v64, v65
  v_mfma_f32_32x32x8_bf16 v[80:95], v[36:37], v[28:29], v[80:95]
  ds_read_b128 v[32:35], v2 offset:7680
  ds_read_b64 v[36:37], v3 offset:7680
  v_exp_f32 v68, v68
  v_exp_f32 v69, v69
  v_cvt_pk_bf16_f32 v49, v66, v67
  s_mov_b32 m0, s42
  s_add_u32 s42, s42, 4096
  buffer_load_dwordx4 v15, s[12:15], s43 offen sc1 lds
  s_add_u32 s43, s43, 4096
  v_exp_f32 v70, v70
  v_exp_f32 v71, v71
  v_cvt_pk_bf16_f32 v50, v68, v69
  v_mfma_f32_32x32x16_bf16 v[112:127], v[40:43], v[56:59], v[112:127]
  v_exp_f32 v72, v72
  v_exp_f32 v73, v73
  v_cvt_pk_bf16_f32 v51, v70, v71
  v_exp_f32 v74, v74
  v_exp_f32 v75, v75
  v_cvt_pk_bf16_f32 v52, v72, v73
  v_mfma_f32_32x32x16_bf16 v[112:127], v[44:47], v[60:63], v[112:127]
  s_mov_b64 exec, s[30:31]
  ds_read_b128 v[40:43], v4 offset:5120
  ds_read_b128 v[44:47], v4 offset:5760
  s_mov_b64 exec, -1
  v_exp_f32 v76, v76
  v_exp_f32 v77, v77
  v_cvt_pk_bf16_f32 v53, v74, v75
  s_mov_b32 m0, s42
  s_add_u32 s42, s42, 4096
  buffer_load_dwordx4 v15, s[12:15], s43 offen sc1 lds
  s_add_u32 s43, s43, 4096
  v_exp_f32 v78, v78
  v_exp_f32 v79, v79
  v_cvt_pk_bf16_f32 v54, v76, v77
  v_cvt_pk_bf16_f32 v55, v78, v79
  s_waitcnt lgkmcnt(2)
  v_mfma_f32_32x32x16_bf16 v[64:79], v[32:35], v[16:19], v[128:143]
  v_exp_f32 v80, v80
  v_exp_f32 v81, v81
  v_exp_f32 v82, v82
  v_exp_f32 v83, v83
  v_cvt_pk_bf16_f32 v56, v80, v81
  v_mfma_f32_32x32x8_bf16 v[64:79], v[36:37], v[20:21], v[64:79]
  v_exp_f32 v84, v84
  v_exp_f32 v85, v85
  v_cvt_pk_bf16_f32 v57, v82, v83
  s_mov_b32 m0, s42
  s_add_u32 s42, s42, 4096
  buffer_load_dwordx4 v15, s[12:15], s43 offen sc1 lds
  s_add_u32 s43, s43, 4096
  v_exp_f32 v86, v86
  v_exp_f32 v87, v87
  v_cvt_pk_bf16_f32 v58, v84, v85
  s_waitcnt lgkmcnt(0)
  v_mfma_f32_32x32x16_bf16 v[96:111], v[40:43], v[48:51], v[96:111]
  v_exp_f32 v88, v88
  v_exp_f32 v89, v89
  v_cvt_pk_bf16_f32 v59, v86, v87
  v_exp_f32 v90, v90
  v_exp_f32 v91, v91
  v_cvt_pk_bf16_f32 v60, v88, v89
  v_mfma_f32_32x32x16_bf16 v[96:111], v[44:47], v[52:55], v[96:111]
  v_exp_f32 v92, v92
  v_exp_f32 v93, v93
  v_cvt_pk_bf16_f32 v61, v90, v91
  s_mov_b32 m0, s42
  s_add_u32 s42, s42, 4096
  buffer_load_dwordx4 v15, s[12:15], s43 offen sc1 lds
  s_add_u32 s43, s43, 4096
  v_exp_f32 v94, v94
  v_exp_f32 v95, v95
  v_cvt_pk_bf16_f32 v62, v92, v93
  v_cvt_pk_bf16_f32 v63, v94, v95
  v_mfma_f32_32x32x16_bf16 v[80:95], v[32:35], v[24:27], v[144:159]
  v_exp_f32 v64, v64
  v_exp_f32 v65, v65
  v_exp_f32 v66, v66
  v_exp_f32 v67, v67
  v_cvt_pk_bf16_f32 v48, v64, v65
  v_mfma_f32_32x32x8_bf16 v[80:95], v[36:37], v[28:29], v[80:95]
  ds_read_b128 v[32:35], v2 offset:10240
  ds_read_b64 v[36:37], v3 offset:10240
  v_exp_f32 v68, v68
  v_exp_f32 v69, v69
  v_cvt_pk_bf16_f32 v49, v66, v67
  s_mov_b32 m0, s42
  s_add_u32 s42, s42, 4096
  buffer_load_dwordx4 v15, s[12:15], s43 offen sc1 lds
  s_add_u32 s43, s43, 4096
  s_cmp_ge_u32 68, s52
  s_cselect_b32 s53, 81920, 0
  s_cselect_b32 s52, 999, s52
  s_add_u32 s42, s42, s53
  s_add_u32 s43, s43, s53
  v_exp_f32 v70, v70
  v_exp_f32 v71, v71
  v_cvt_pk_bf16_f32 v50, v68, v69
  v_mfma_f32_32x32x16_bf16 v[112:127], v[40:43], v[56:59], v[112:127]
  v_exp_f32 v72, v72
  v_exp_f32 v73, v73
  v_cvt_pk_bf16_f32 v51, v70, v71
  v_exp_f32 v74, v74
  v_exp_f32 v75, v75
  v_cvt_pk_bf16_f32 v52, v72, v73
  v_mfma_f32_32x32x16_bf16 v[112:127], v[44:47], v[60:63], v[112:127]
  s_mov_b64 exec, s[30:31]
  ds_read_b128 v[40:43], v4 offset:7680
  ds_read_b128 v[44:47], v4 offset:8320
  s_mov_b64 exec, -1
  v_exp_f32 v76, v76
  v_exp_f32 v77, v77
  v_cvt_pk_bf16_f32 v53, v74, v75
  s_mov_b32 m0, s42
  s_add_u32 s42, s42, 4096
  buffer_load_dwordx4 v15, s[12:15], s43 offen sc1 lds
  s_add_u32 s43, s43, 4096
  s_cmp_ge_u32 72, s52
  s_cselect_b32 s53, 81920, 0
  s_cselect_b32 s52, 999, s52
  s_add_u32 s42, s42, s53
  s_add_u32 s43, s43, s53
  v_exp_f32 v78, v78
  v_exp_f32 v79, v79
  v_cvt_pk_bf16_f32 v54, v76, v77
  v_cvt_pk_bf16_f32 v55, v78, v79
  s_waitcnt lgkmcnt(2)
  v_mfma_f32_32x32x16_bf16 v[64:79], v[32:35], v[16:19], v[128:143]
  v_exp_f32 v80, v80
  v_exp_f32 v81, v81
  v_exp_f32 v82, v82
  v_exp_f32 v83, v83
  v_cvt_pk_bf16_f32 v56, v80, v81
  v_mfma_f32_32x32x8_bf16 v[64:79], v[36:37], v[20:21], v[64:79]
  v_exp_f32 v84, v84
  v_exp_f32 v85, v85
  v_cvt_pk_bf16_f32 v57, v82, v83
  s_mov_b32 m0, s42
  s_add_u32 s42, s42, 4096
  buffer_load_dwordx4 v15, s[12:15], s43 offen sc1 lds
  s_add_u32 s43, s43, 4096
  v_exp_f32 v86, v86
  v_exp_f32 v87, v87
  v_cvt_pk_bf16_f32 v58, v84, v85
  s_waitcnt lgkmcnt(0)
  v_mfma_f32_32x32x16_bf16 v[96:111], v[40:43], v[48:51], v[96:111]
  v_exp_f32 v88, v88
  v_exp_f32 v89, v89
  v_cvt_pk_bf16_f32 v59, v86, v87
  v_exp_f32 v90, v90
  v_exp_f32 v91, v91
  v_cvt_pk_bf16_f32 v60, v88, v89
  v_mfma_f32_32x32x16_bf16 v[96:111], v[44:47], v[52:55], v[96:111]
  v_exp_f32 v92, v92
  v_exp_f32 v93, v93
  v_cvt_pk_bf16_f32 v61, v90, v91
  s_mov_b32 m0, s42
  s_add_u32 s42, s42, 4096
  buffer_load_dwordx4 v15, s[12:15], s43 offen sc1 lds
  s_add_u32 s43, s43, 4096
  v_exp_f32 v94, v94
  v_exp_f32 v95, v95
  v_cvt_pk_bf16_f32 v62, v92, v93
  v_cvt_pk_bf16_f32 v63, v94, v95
  v_add_u32 v2, 10240, v2
  v_add_u32 v3, 10240, v3
  v_add_u32 v4, 10240, v4
  s_add_u32 s34, s34, 1
  s_waitcnt vmcnt(12)
  s_barrier
  v_mov_b32 v9, 0
  v_lshlrev_b32 v10, 2, v1
  ds_write_b32 v10, v9 offset:0
  s_cmp_eq_u32 s91, 0
  s_cbranch_scc1 LT_noh
  s_cmp_eq_u32 s91, 3
  s_cbranch_scc1 LT_rl
  v_bfe_u32 v11, v1, 4, 1
  v_mul_u32_u24 v11, 70656, v11
  v_lshrrev_b32 v12, 5, v1
  v_lshl_add_u32 v11, v12, 8, v11
  v_and_b32 v12, 15, v1
  v_lshl_add_u32 v11, v12, 4, v11
  s_cmp_eq_u32 s91, 2
  s_cselect_b32 s86, 0x40000000, s88
  s_cselect_b32 s87, 0x40000000, s89
  buffer_store_dwordx4 v[180:183], v11, s[24:27], s88 offen offset:0 sc1
  buffer_store_dwordx4 v[176:179], v11, s[24:27], s89 offen offset:0 sc1
  buffer_store_dwordx4 v[196:199], v11, s[24:27], s86 offen offset:512 sc1
  buffer_store_dwordx4 v[192:195], v11, s[24:27], s87 offen offset:512 sc1
  buffer_store_dwordx4 v[212:215], v11, s[24:27], s86 offen offset:1024 sc1
  buffer_store_dwordx4 v[208:211], v11, s[24:27], s87 offen offset:1024 sc1
  buffer_store_dwordx4 v[228:231], v11, s[24:27], s86 offen offset:1536 sc1
  buffer_store_dwordx4 v[224:227], v11, s[24:27], s87 offen offset:1536 sc1
  buffer_store_dwordx4 v[244:247], v11, s[24:27], s86 offen offset:2048 sc1
  buffer_store_dwordx4 v[240:243], v11, s[24:27], s87 offen offset:2048 sc1
  s_branch LT_noh
LT_rl:
  buffer_store_dwordx4 v[160:163], v15, s[24:27], s88 offen offset:0 sc1
  buffer_store_dwordx4 v[164:167], v15, s[24:27], s88 offen offset:1024 sc1
  buffer_store_dwordx4 v[168:171], v15, s[24:27], s88 offen offset:2048 sc1
  buffer_store_dwordx4 v[172:175], v15, s[24:27], s88 offen offset:3072 sc1
  buffer_store_dwordx4 v[176:179], v15, s[24:27], s89 offen offset:0 sc1
LT_noh:
  v_mov_b32 v208, 0
  v_mov_b32 v222, 0
  v_mov_b32 v223, 0
  v_mov_b32 v224, 0
  v_mov_b32 v225, 0
  .p2align 6
L2_loopB:
  v_mfma_f32_32x32x16_bf16 v[80:95], v[32:35], v[24:27], v[144:159]
  v_exp_f32 v64, v64
  v_exp_f32 v65, v65
  v_exp_f32 v66, v66
  v_exp_f32 v67, v67
  v_cvt_pk_bf16_f32 v48, v64, v65
  v_mfma_f32_32x32x8_bf16 v[80:95], v[36:37], v[28:29], v[80:95]
  ds_read_b128 v[32:35], v2 offset:2560
  ds_read_b64 v[36:37], v3 offset:2560
  v_exp_f32 v68, v68
  v_exp_f32 v69, v69
  v_cvt_pk_bf16_f32 v49, v66, v67
  v_exp_f32 v70, v70
  v_exp_f32 v71, v71
  v_cvt_pk_bf16_f32 v50, v68, v69
  v_mfma_f32_32x32x16_bf16 v[112:127], v[40:43], v[56:59], v[112:127]
  v_exp_f32 v72, v72
  v_exp_f32 v73, v73
  v_cvt_pk_bf16_f32 v51, v70, v71
  v_exp_f32 v74, v74
  v_exp_f32 v75, v75
  v_cvt_pk_bf16_f32 v52, v72, v73
  v_mfma_f32_32x32x16_bf16 v[112:127], v[44:47], v[60:63], v[112:127]
  s_mov_b64 exec, s[30:31]
  ds_read_b128 v[40:43], v4 offset:0
  ds_read_b128 v[44:47], v4 offset:640
  s_mov_b64 exec, -1
  v_exp_f32 v76, v76
  v_exp_f32 v77, v77
  v_cvt_pk_bf16_f32 v53, v74, v75
  v_exp_f32 v78, v78
  v_exp_f32 v79, v79
  v_cvt_pk_bf16_f32 v54, v76, v77
  v_cvt_pk_bf16_f32 v55, v78, v79
  s_waitcnt lgkmcnt(2)
  v_mfma_f32_32x32x16_bf16 v[64:79], v[32:35], v[16:19], v[128:143]
  v_exp_f32 v80, v80
  v_exp_f32 v81, v81
  v_exp_f32 v82, v82
  v_exp_f32 v83, v83
  v_cvt_pk_bf16_f32 v56, v80, v81
  v_mfma_f32_32x32x8_bf16 v[64:79], v[36:37], v[20:21], v[64:79]
  v_exp_f32 v84, v84
  v_exp_f32 v85, v85
  v_cvt_pk_bf16_f32 v57, v82, v83
  v_exp_f32 v86, v86
  v_exp_f32 v87, v87
  v_cvt_pk_bf16_f32 v58, v84, v85
  s_waitcnt lgkmcnt(0)
  v_mfma_f32_32x32x16_bf16 v[96:111], v[40:43], v[48:51], v[96:111]
  v_exp_f32 v88, v88
  v_exp_f32 v89, v89
  v_cvt_pk_bf16_f32 v59, v86, v87
  v_exp_f32 v90, v90
  v_exp_f32 v91, v91
  v_cvt_pk_bf16_f32 v60, v88, v89
  v_mfma_f32_32x32x16_bf16 v[96:111], v[44:47], v[52:55], v[96:111]
  v_exp_f32 v92, v92
  v_exp_f32 v93, v93
  v_cvt_pk_bf16_f32 v61, v90, v91
  v_exp_f32 v94, v94
  v_exp_f32 v95, v95
  v_cvt_pk_bf16_f32 v62, v92, v93
  v_cvt_pk_bf16_f32 v63, v94, v95
  v_mfma_f32_32x32x16_bf16 v[80:95], v[32:35], v[24:27], v[144:159]
  v_exp_f32 v64, v64
  v_exp_f32 v65, v65
  v_exp_f32 v66, v66
  v_exp_f32 v67, v67
  v_cvt_pk_bf16_f32 v48, v64, v65
  v_mfma_f32_32x32x8_bf16 v[80:95], v[36:37], v[28:29], v[80:95]
  ds_read_b128 v[32:35], v2 offset:5120
  ds_read_b64 v[36:37], v3 offset:5120
  v_exp_f32 v68, v68
  v_exp_f32 v69, v69
  v_cvt_pk_bf16_f32 v49, v66, v67
  v_exp_f32 v70, v70
  v_exp_f32 v71, v71
  v_cvt_pk_bf16_f32 v50, v68, v69
  v_mfma_f32_32x32x16_bf16 v[112:127], v[40:43], v[56:59], v[112:127]
  v_exp_f32 v72, v72
  v_exp_f32 v73, v73
  v_cvt_pk_bf16_f32 v51, v70, v71
  v_exp_f32 v74, v74
  v_exp_f32 v75, v75
  v_cvt_pk_bf16_f32 v52, v72, v73
  v_mfma_f32_32x32x16_bf16 v[112:127], v[44:47], v[60:63], v[112:127]
  s_mov_b64 exec, s[30:31]
  ds_read_b128 v[40:43], v4 offset:2560
  ds_read_b128 v[44:47], v4 offset:3200
  s_mov_b64 exec, -1
  v_exp_f32 v76, v76
  v_exp_f32 v77, v77
  v_cvt_pk_bf16_f32 v53, v74, v75
  v_exp_f32 v78, v78
  v_exp_f32 v79, v79
  v_cvt_pk_bf16_f32 v54, v76, v77
  v_cvt_pk_bf16_f32 v55, v78, v79
  s_waitcnt lgkmcnt(2)
  v_mfma_f32_32x32x16_bf16 v[64:79], v[32:35], v[16:19], v[128:143]
  v_exp_f32 v80, v80
  v_exp_f32 v81, v81
  v_exp_f32 v82, v82
  v_exp_f32 v83, v83
  v_cvt_pk_bf16_f32 v56, v80, v81
  v_mfma_f32_32x32x8_bf16 v[64:79], v[36:37], v[20:21], v[64:79]
  v_exp_f32 v84, v84
  v_exp_f32 v85, v85
  v_cvt_pk_bf16_f32 v57, v82, v83
  v_exp_f32 v86, v86
  v_exp_f32 v87, v87
  v_cvt_pk_bf16_f32 v58, v84, v85
  s_waitcnt lgkmcnt(0)
  v_mfma_f32_32x32x16_bf16 v[96:111], v[40:43], v[48:51], v[96:111]
  v_exp_f32 v88, v88
  v_exp_f32 v89, v89
  v_cvt_pk_bf16_f32 v59, v86, v87
  v_exp_f32 v90, v90
  v_exp_f32 v91, v91
  v_cvt_pk_bf16_f32 v60, v88, v89
  v_mfma_f32_32x32x16_bf16 v[96:111], v[44:47], v[52:55], v[96:111]
  v_exp_f32 v92, v92
  v_exp_f32 v93, v93
  v_cvt_pk_bf16_f32 v61, v90, v91
  v_exp_f32 v94, v94
  v_exp_f32 v95, v95
  v_cvt_pk_bf16_f32 v62, v92, v93
  v_cvt_pk_bf16_f32 v63, v94, v95
  v_mfma_f32_32x32x16_bf16 v[80:95], v[32:35], v[24:27], v[144:159]
  v_exp_f32 v64, v64
  v_exp_f32 v65, v65
  v_exp_f32 v66, v66
  v_exp_f32 v67, v67
  v_cvt_pk_bf16_f32 v48, v64, v65
  v_mfma_f32_32x32x8_bf16 v[80:95], v[36:37], v[28:29], v[80:95]
  ds_read_b128 v[32:35], v2 offset:7680
  ds_read_b64 v[36:37], v3 offset:7680
  v_exp_f32 v68, v68
  v_exp_f32 v69, v69
  v_cvt_pk_bf16_f32 v49, v66, v67
  v_exp_f32 v70, v70
  v_exp_f32 v71, v71
  v_cvt_pk_bf16_f32 v50, v68, v69
  v_mfma_f32_32x32x16_bf16 v[112:127], v[40:43], v[56:59], v[112:127]
  v_exp_f32 v72, v72
  v_exp_f32 v73, v73
  v_cvt_pk_bf16_f32 v51, v70, v71
  v_exp_f32 v74, v74
  v_exp_f32 v75, v75
  v_cvt_pk_bf16_f32 v52, v72, v73
  v_mfma_f32_32x32x16_bf16 v[112:127], v[44:47], v[60:63], v[112:127]
  s_mov_b64 exec, s[30:31]
  ds_read_b128 v[40:43], v4 offset:5120
  ds_read_b128 v[44:47], v4 offset:5760
  s_mov_b64 exec, -1
  v_exp_f32 v76, v76
  v_exp_f32 v77, v77
  v_cvt_pk_bf16_f32 v53, v74, v75
  v_exp_f32 v78, v78
  v_exp_f32 v79, v79
  v_cvt_pk_bf16_f32 v54, v76, v77
  v_cvt_pk_bf16_f32 v55, v78, v79
  s_waitcnt lgkmcnt(2)
  v_mfma_f32_32x32x16_bf16 v[64:79], v[32:35], v[16:19], v[128:143]
  v_exp_f32 v80, v80
  v_exp_f32 v81, v81
  v_exp_f32 v82, v82
  v_exp_f32 v83, v83
  v_cvt_pk_bf16_f32 v56, v80, v81
  v_mfma_f32_32x32x8_bf16 v[64:79], v[36:37], v[20:21], v[64:79]
  v_exp_f32 v84, v84
  v_exp_f32 v85, v85
  v_cvt_pk_bf16_f32 v57, v82, v83
  v_exp_f32 v86, v86
  v_exp_f32 v87, v87
  v_cvt_pk_bf16_f32 v58, v84, v85
  s_waitcnt lgkmcnt(0)
  v_mfma_f32_32x32x16_bf16 v[96:111], v[40:43], v[48:51], v[96:111]
  v_exp_f32 v88, v88
  v_exp_f32 v89, v89
  v_cvt_pk_bf16_f32 v59, v86, v87
  v_exp_f32 v90, v90
  v_exp_f32 v91, v91
  v_cvt_pk_bf16_f32 v60, v88, v89
  v_mfma_f32_32x32x16_bf16 v[96:111], v[44:47], v[52:55], v[96:111]
  v_exp_f32 v92, v92
  v_exp_f32 v93, v93
  v_cvt_pk_bf16_f32 v61, v90, v91
  v_exp_f32 v94, v94
  v_exp_f32 v95, v95
  v_cvt_pk_bf16_f32 v62, v92, v93
  v_cvt_pk_bf16_f32 v63, v94, v95
  v_mfma_f32_32x32x16_bf16 v[80:95], v[32:35], v[24:27], v[144:159]
  v_exp_f32 v64, v64
  v_exp_f32 v65, v65
  v_exp_f32 v66, v66
  v_exp_f32 v67, v67
  v_cvt_pk_bf16_f32 v48, v64, v65
  v_mfma_f32_32x32x8_bf16 v[80:95], v[36:37], v[28:29], v[80:95]
  ds_read_b128 v[32:35], v2 offset:10240
  ds_read_b64 v[36:37], v3 offset:10240
  v_exp_f32 v68, v68
  v_exp_f32 v69, v69
  v_cvt_pk_bf16_f32 v49, v66, v67
  v_exp_f32 v70, v70
  v_exp_f32 v71, v71
  v_cvt_pk_bf16_f32 v50, v68, v69
  v_mfma_f32_32x32x16_bf16 v[112:127], v[40:43], v[56:59], v[112:127]
  v_exp_f32 v72, v72
  v_exp_f32 v73, v73
  v_cvt_pk_bf16_f32 v51, v70, v71
  v_exp_f32 v74, v74
  v_exp_f32 v75, v75
  v_cvt_pk_bf16_f32 v52, v72, v73
  v_mfma_f32_32x32x16_bf16 v[112:127], v[44:47], v[60:63], v[112:127]
  s_mov_b64 exec, s[30:31]
  ds_read_b128 v[40:43], v4 offset:7680
  ds_read_b128 v[44:47], v4 offset:8320
  s_mov_b64 exec, -1
  v_exp_f32 v76, v76
  v_exp_f32 v77, v77
  v_cvt_pk_bf16_f32 v53, v74, v75
  v_exp_f32 v78, v78
  v_exp_f32 v79, v79
  v_cvt_pk_bf16_f32 v54, v76, v77
  v_cvt_pk_bf16_f32 v55, v78, v79
  s_waitcnt lgkmcnt(2)
  v_mfma_f32_32x32x16_bf16 v[64:79], v[32:35], v[16:19], v[128:143]
  v_exp_f32 v80, v80
  v_exp_f32 v81, v81
  v_exp_f32 v82, v82
  v_exp_f32 v83, v83
  v_cvt_pk_bf16_f32 v56, v80, v81
  v_mfma_f32_32x32x8_bf16 v[64:79], v[36:37], v[20:21], v[64:79]
  v_exp_f32 v84, v84
  v_exp_f32 v85, v85
  v_cvt_pk_bf16_f32 v57, v82, v83
  v_exp_f32 v86, v86
  v_exp_f32 v87, v87
  v_cvt_pk_bf16_f32 v58, v84, v85
  s_waitcnt lgkmcnt(0)
  v_mfma_f32_32x32x16_bf16 v[96:111], v[40:43], v[48:51], v[96:111]
  v_exp_f32 v88, v88
  v_exp_f32 v89, v89
  v_cvt_pk_bf16_f32 v59, v86, v87
  v_exp_f32 v90, v90
  v_exp_f32 v91, v91
  v_cvt_pk_bf16_f32 v60, v88, v89
  v_mfma_f32_32x32x16_bf16 v[96:111], v[44:47], v[52:55], v[96:111]
  v_exp_f32 v92, v92
  v_exp_f32 v93, v93
  v_cvt_pk_bf16_f32 v61, v90, v91
  v_exp_f32 v94, v94
  v_exp_f32 v95, v95
  v_cvt_pk_bf16_f32 v62, v92, v93
  v_cvt_pk_bf16_f32 v63, v94, v95
  v_add_u32 v2, 10240, v2
  v_add_u32 v3, 10240, v3
  v_add_u32 v4, 10240, v4
  s_add_u32 s34, s34, 1
  s_cmp_eq_u32 s34, 2
  s_cbranch_scc1 L2_w2
  s_cmp_lt_u32 s34, s63
  s_cbranch_scc1 L2_loopB
  s_branch L2_done
L2_w2:
  s_waitcnt vmcnt(0) lgkmcnt(0)
  s_barrier
  v_mov_b32 v9, 0
  s_cmp_lg_u32 s3, 0
  s_cbranch_scc1 LT_nosig2
  s_cmp_eq_u32 s91, 0
  s_cbranch_scc1 LT_nosig2
  s_lshl_b32 s36, s2, 7
  s_add_u32 s36, s36, 131072
  v_mov_b32 v10, s90
  s_mov_b64 exec, 1
  buffer_store_dword v10, v9, s[24:27], s36 offen sc1
  s_mov_b64 exec, -1
LT_nosig2:
  s_branch L2_loopB
L2_done:
  s_waitcnt vmcnt(0)
  v_mfma_f32_32x32x16_bf16 v[112:127], v[40:43], v[56:59], v[112:127]
  v_mfma_f32_32x32x16_bf16 v[112:127], v[44:47], v[60:63], v[112:127]
  s_and_b32 s36, s3, 3
  s_lshl_b32 s37, s36, 12
  v_add_u32 v5, s37, v15
  v_add_u32 v6, 71680, v5
  s_lshl_b32 s36, s36, 2
  v_mov_b32 v4, s36
  s_cmp_ge_u32 s3, 4
  s_cbranch_scc1 L2_hi
  v_mov_b32 v111, v128
  ds_write_b128 v5, v[96:99] offset:1024
  ds_write_b128 v5, v[100:103] offset:2048
  ds_write_b128 v5, v[104:107] offset:3072
  ds_write_b128 v5, v[108:111] offset:4096
  v_mov_b32 v127, v144
  ds_write_b128 v6, v[112:115] offset:0
  ds_write_b128 v6, v[116:119] offset:1024
  ds_write_b128 v6, v[120:123] offset:2048
  ds_write_b128 v6, v[124:127] offset:3072
  v_mov_b32 v7, 1
  s_waitcnt lgkmcnt(0)
  ds_write_b32 v4, v7 offset:0
  s_setprio 0
  s_branch L3_start
L2_hi:
L2_fw:
  ds_read_b32 v7, v4 offset:0
  s_waitcnt lgkmcnt(0)
  v_readfirstlane_b32 s36, v7
  s_nop 1
  s_cmp_lg_u32 s36, 0
  s_cbranch_scc1 L2_fok
  s_sleep 4
  s_branch L2_fw
L2_fok:
  ds_read_b128 v[64:67], v5 offset:1024
  ds_read_b128 v[68:71], v5 offset:2048
  ds_read_b128 v[72:75], v5 offset:3072
  ds_read_b128 v[76:79], v5 offset:4096
  ds_read_b128 v[80:83], v6 offset:0
  ds_read_b128 v[84:87], v6 offset:1024
  ds_read_b128 v[88:91], v6 offset:2048
  ds_read_b128 v[92:95], v6 offset:3072
  v_bfe_u32 v2, v1, 4, 1
  v_mul_u32_u24 v2, 70656, v2
  v_and_b32 v3, 15, v1
  v_lshl_add_u32 v2, v3, 4, v2
  v_lshrrev_b32 v3, 5, v1
  v_lshl_add_u32 v3, v3, 8, v2
  s_waitcnt lgkmcnt(4)
  v_min_f32 v7, v128, v79
  v_sub_f32 v8, v7, v128
  v_sub_f32 v9, v7, v79
  v_exp_f32 v8, v8
  v_exp_f32 v9, v9
  v_mul_f32 v96, v96, v8
  v_mul_f32 v97, v97, v8
  v_mul_f32 v98, v98, v8
  v_mul_f32 v99, v99, v8
  v_mul_f32 v100, v100, v8
  v_mul_f32 v101, v101, v8
  v_mul_f32 v102, v102, v8
  v_mul_f32 v103, v103, v8
  v_mul_f32 v104, v104, v8
  v_mul_f32 v105, v105, v8
  v_mul_f32 v106, v106, v8
  v_mul_f32 v107, v107, v8
  v_mul_f32 v108, v108, v8
  v_fmac_f32 v96, v64, v9
  v_fmac_f32 v97, v65, v9
  v_fmac_f32 v98, v66, v9
  v_fmac_f32 v99, v67, v9
  v_fmac_f32 v100, v68, v9
  v_fmac_f32 v101, v69, v9
  v_fmac_f32 v102, v70, v9
  v_fmac_f32 v103, v71, v9
  v_fmac_f32 v104, v72, v9
  v_fmac_f32 v105, v73, v9
  v_fmac_f32 v106, v74, v9
  v_fmac_f32 v107, v75, v9
  v_fmac_f32 v108, v76, v9
  s_waitcnt lgkmcnt(0)
  v_min_f32 v7, v144, v95
  v_sub_f32 v8, v7, v144
  v_sub_f32 v9, v7, v95
  v_exp_f32 v8, v8
  v_exp_f32 v9, v9
  v_mul_f32 v112, v112, v8
  v_mul_f32 v113, v113, v8
  v_mul_f32 v114, v114, v8
  v_mul_f32 v115, v115, v8
  v_mul_f32 v116, v116, v8
  v_mul_f32 v117, v117, v8
  v_mul_f32 v118, v118, v8
  v_mul_f32 v119, v119, v8
  v_mul_f32 v120, v120, v8
  v_mul_f32 v121, v121, v8
  v_mul_f32 v122, v122, v8
  v_mul_f32 v123, v123, v8
  v_mul_f32 v124, v124, v8
  v_fmac_f32 v112, v80, v9
  v_fmac_f32 v113, v81, v9
  v_fmac_f32 v114, v82, v9
  v_fmac_f32 v115, v83, v9
  v_fmac_f32 v116, v84, v9
  v_fmac_f32 v117, v85, v9
  v_fmac_f32 v118, v86, v9
  v_fmac_f32 v119, v87, v9
  v_fmac_f32 v120, v88, v9
  v_fmac_f32 v121, v89, v9
  v_fmac_f32 v122, v90, v9
  v_fmac_f32 v123, v91, v9
  v_fmac_f32 v124, v92, v9
L2_chk:
  v_cndmask_b32 v7, v108, v104, s[32:33]
  v_mov_b32 v8, 0x5f800000
  v_cmp_nle_f32 vcc, v7, v8
  s_nop 4
  s_cbranch_vccnz L2_slow
L2_fin:
  v_mul_f32 v8, v13, v13
  v_mul_f32 v8, v7, v8
  v_rcp_f32 v8, v8
  s_mul_i32 s36, s35, 141312
  s_add_u32 s36, s36, 10551296
  s_lshr_b32 s37, s28, 1
  s_mul_i32 s37, s37, 1280
  s_add_u32 s36, s36, s37
  s_and_b32 s37, s28, 1
  s_mul_i32 s38, s37, 768
  s_add_u32 s38, s38, s36
  s_lshl_b32 s37, s37, 3
  s_add_u32 s39, s37, s36
  v_mul_f32 v96, v96, v8
  v_mul_f32 v97, v97, v8
  v_mul_f32 v98, v98, v8
  v_mul_f32 v99, v99, v8
  v_mul_f32 v100, v100, v8
  v_mul_f32 v101, v101, v8
  v_mul_f32 v102, v102, v8
  v_mul_f32 v103, v103, v8
  v_mul_f32 v104, v104, v8
  v_mul_f32 v105, v105, v8
  v_mul_f32 v106, v106, v8
  v_mul_f32 v107, v107, v8
  v_cvt_pk_bf16_f32 v48, v96, v97
  v_cvt_pk_bf16_f32 v49, v98, v99
  v_cvt_pk_bf16_f32 v50, v100, v101
  v_cvt_pk_bf16_f32 v51, v102, v103
  v_cvt_pk_bf16_f32 v52, v104, v105
  v_cvt_pk_bf16_f32 v53, v106, v107
  buffer_store_dwordx4 v[48:51], v3, s[24:27], s38 offen sc1
  s_mov_b32 exec_hi, 0
  buffer_store_dwordx2 v[52:53], v2, s[24:27], s39 offen offset:512 sc1
  s_mov_b64 exec, -1
  s_cmp_eq_u32 s46, 2
  s_cbranch_scc1 L3_fb_next
  s_cmp_eq_u32 s46, 1
  s_cbranch_scc1 L2_sig
  s_mov_b32 s46, 1
  s_add_u32 s35, s35, 1
  v_mov_b32 v96, v112
  v_mov_b32 v97, v113
  v_mov_b32 v98, v114
  v_mov_b32 v99, v115
  v_mov_b32 v100, v116
  v_mov_b32 v101, v117
  v_mov_b32 v102, v118
  v_mov_b32 v103, v119
  v_mov_b32 v104, v120
  v_mov_b32 v105, v121
  v_mov_b32 v106, v122
  v_mov_b32 v107, v123
  v_mov_b32 v108, v124
  v_mov_b32 v16, v24
  v_mov_b32 v17, v25
  v_mov_b32 v18, v26
  v_mov_b32 v19, v27
  v_mov_b32 v20, v28
  v_mov_b32 v21, v29
  v_mov_b32 v13, v14
  s_branch L2_chk
L2_sig:
  s_waitcnt vmcnt(0)
  v_mov_b32 v7, 1
  v_mov_b32 v8, 0
  s_mov_b64 exec, 1
  ds_add_rtn_u32 v9, v8, v7 offset:16
  s_waitcnt lgkmcnt(0)
  v_readfirstlane_b32 s36, v9
  s_nop 1
  s_cmp_lg_u32 s36, 3
  s_cbranch_scc1 L2_out
  s_lshl_b32 s36, s2, 7
  s_add_u32 s36, s36, 65536
  v_mov_b32 v7, s90
  buffer_store_dword v7, v8, s[24:27], s36 offen sc1
  s_branch L2_out
L2_slow:
  v_mov_b32 v96, 0
  v_mov_b32 v97, 0
  v_mov_b32 v98, 0
  v_mov_b32 v99, 0
  v_mov_b32 v100, 0
  v_mov_b32 v101, 0
  v_mov_b32 v102, 0
  v_mov_b32 v103, 0
  v_mov_b32 v104, 0
  v_mov_b32 v105, 0
  v_mov_b32 v106, 0
  v_mov_b32 v107, 0
  v_mov_b32 v108, 0
  v_mov_b32 v109, 0
  v_mov_b32 v110, 0
  v_mov_b32 v111, 0
  v_mov_b32 v10, 0xff800000
  v_and_b32 v5, 31, v1
  v_lshrrev_b32 v6, 5, v1
  v_lshlrev_b32 v12, 3, v5
  v_add_u32 v12, 1024, v12
  v_mul_u32_u24 v11, 320, v6
  v_lshl_add_u32 v11, v5, 4, v11
  v_add_u32 v11, 1280, v11
  s_mul_i32 s43, s28, 163840
  s_mov_b32 s34, 0
L2_sloop:
  buffer_load_dwordx4 v[32:35], v15, s[12:15], s43 offen sc1
  buffer_load_dwordx2 v[36:37], v12, s[12:15], s43 offen sc1
  s_mov_b64 exec, s[30:31]
  buffer_load_dwordx4 v[40:43], v11, s[12:15], s43 offen sc1
  buffer_load_dwordx4 v[44:47], v11, s[12:15], s43 offen offset:640 sc1
  s_mov_b64 exec, -1
  s_waitcnt vmcnt(0)
  v_mfma_f32_32x32x16_bf16 v[64:79], v[32:35], v[16:19], 0
  v_mfma_f32_32x32x8_bf16 v[64:79], v[36:37], v[20:21], v[64:79]
  s_nop 11
  v_max3_f32 v5, v64, v65, v10
  v_max3_f32 v5, v66, v67, v5
  v_max3_f32 v5, v68, v69, v5
  v_max3_f32 v5, v70, v71, v5
  v_max3_f32 v5, v72, v73, v5
  v_max3_f32 v5, v74, v75, v5
  v_max3_f32 v5, v76, v77, v5
  v_max3_f32 v5, v78, v79, v5
  v_mov_b32 v6, v5
  s_nop 1
  v_permlane32_swap_b32 v5, v6
  v_max_f32 v5, v5, v6
  v_sub_f32 v6, v10, v5
  v_exp_f32 v6, v6
  v_mov_b32 v10, v5
  v_sub_f32 v64, v64, v5
  v_sub_f32 v65, v65, v5
  v_sub_f32 v66, v66, v5
  v_sub_f32 v67, v67, v5
  v_sub_f32 v68, v68, v5
  v_sub_f32 v69, v69, v5
  v_sub_f32 v70, v70, v5
  v_sub_f32 v71, v71, v5
  v_sub_f32 v72, v72, v5
  v_sub_f32 v73, v73, v5
  v_sub_f32 v74, v74, v5
  v_sub_f32 v75, v75, v5
  v_sub_f32 v76, v76, v5
  v_sub_f32 v77, v77, v5
  v_sub_f32 v78, v78, v5
  v_sub_f32 v79, v79, v5
  v_exp_f32 v64, v64
  v_exp_f32 v65, v65
  v_exp_f32 v66, v66
  v_exp_f32 v67, v67
  v_exp_f32 v68, v68
  v_exp_f32 v69, v69
  v_exp_f32 v70, v70
  v_exp_f32 v71, v71
  v_exp_f32 v72, v72
  v_exp_f32 v73, v73
  v_exp_f32 v74, v74
  v_exp_f32 v75, v75
  v_exp_f32 v76, v76
  v_exp_f32 v77, v77
  v_exp_f32 v78, v78
  v_exp_f32 v79, v79
  v_mul_f32 v96, v96, v6
  v_mul_f32 v97, v97, v6
  v_mul_f32 v98, v98, v6
  v_mul_f32 v99, v99, v6
  v_mul_f32 v100, v100, v6
  v_mul_f32 v101, v101, v6
  v_mul_f32 v102, v102, v6
  v_mul_f32 v103, v103, v6
  v_mul_f32 v104, v104, v6
  v_mul_f32 v105, v105, v6
  v_mul_f32 v106, v106, v6
  v_mul_f32 v107, v107, v6
  v_mul_f32 v108, v108, v6
  v_mul_f32 v109, v109, v6
  v_mul_f32 v110, v110, v6
  v_mul_f32 v111, v111, v6
  v_cvt_pk_bf16_f32 v48, v64, v65
  v_cvt_pk_bf16_f32 v49, v66, v67
  v_cvt_pk_bf16_f32 v50, v68, v69
  v_cvt_pk_bf16_f32 v51, v70, v71
  v_cvt_pk_bf16_f32 v52, v72, v73
  v_cvt_pk_bf16_f32 v53, v74, v75
  v_cvt_pk_bf16_f32 v54, v76, v77
  v_cvt_pk_bf16_f32 v55, v78, v79
  v_mfma_f32_32x32x16_bf16 v[96:111], v[40:43], v[48:51], v[96:111]
  s_nop 0
  v_mfma_f32_32x32x16_bf16 v[96:111], v[44:47], v[52:55], v[96:111]
  s_add_u32 s43, s43, 2560
  s_add_u32 s34, s34, 1
  s_cmp_lt_u32 s34, 64
  s_nop 7
  s_cbranch_scc1 L2_sloop
  s_nop 7
  v_cndmask_b32 v7, v108, v104, s[32:33]
  s_branch L2_fin
L3_start:
  v_lshlrev_b32 v5, 7, v1
  v_min_u32 v6, 31, v1
  v_lshlrev_b32 v6, 7, v6
  s_mov_b32 s36, 143360
  s_mov_b32 s38, 151552
  s_mov_b32 s39, 159744
  s_mov_b32 s37, 20000
L3_hp:
  buffer_load_dword v7, v5, s[24:27], s36 offen sc1
  buffer_load_dword v8, v5, s[24:27], s38 offen sc1
  buffer_load_dword v9, v6, s[24:27], s39 offen sc1
  s_waitcnt vmcnt(0)
  v_xor_b32 v7, s90, v7
  v_xor_b32 v8, s90, v8
  v_xor_b32 v9, s90, v9
  v_or3_b32 v7, v7, v8, v9
  v_cmp_ne_u32 vcc, 0, v7
  s_nop 4
  s_cbranch_vccz L3_hok
  s_sub_u32 s37, s37, 1
  s_cmp_le_i32 s37, 0
  s_cbranch_scc1 L3_hok
  s_sleep 8
  s_branch L3_hp
L3_hok:
  s_add_u32 s40, s3, 20
  s_mul_i32 s54, s5, 348160
  s_mul_i32 s41, s40, 5120
  s_add_u32 s54, s54, s41
  s_add_u32 s54, s54, 20971520
  s_add_u32 s55, s54, 4096
  s_mul_i32 s42, s4, 282624
  s_lshl_b32 s40, s40, 10
  s_add_u32 s42, s42, s40
  s_add_u32 s42, s42, 10551296
  s_add_u32 s43, s3, 0
  s_and_b32 s43, s43, 3
  s_mul_i32 s43, s43, 70656
  s_add_u32 s56, s42, s43
  s_add_u32 s43, s3, 1
  s_and_b32 s43, s43, 3
  s_mul_i32 s43, s43, 70656
  s_add_u32 s57, s42, s43
  s_add_u32 s43, s3, 2
  s_and_b32 s43, s43, 3
  s_mul_i32 s43, s43, 70656
  s_add_u32 s58, s42, s43
  s_add_u32 s43, s3, 3
  s_and_b32 s43, s43, 3
  s_mul_i32 s43, s43, 70656
  s_add_u32 s59, s42, s43
  buffer_load_dwordx4 v[20:23], v15, s[24:27], s56 offen sc1
  s_add_u32 s56, s56, 4096
  buffer_load_dwordx4 v[24:27], v15, s[24:27], s57 offen sc1
  s_add_u32 s57, s57, 4096
  buffer_load_dwordx4 v[28:31], v15, s[24:27], s58 offen sc1
  s_add_u32 s58, s58, 4096
  buffer_load_dwordx4 v[32:35], v15, s[24:27], s59 offen sc1
  s_add_u32 s59, s59, 4096
  buffer_load_dwordx4 v[36:39], v15, s[24:27], s54 offen offset:0 sc1
  buffer_load_dwordx4 v[40:43], v15, s[24:27], s54 offen offset:1024 sc1
  buffer_load_dwordx4 v[44:47], v15, s[24:27], s54 offen offset:2048 sc1
  buffer_load_dwordx4 v[48:51], v15, s[24:27], s54 offen offset:3072 sc1
  buffer_load_dwordx4 v[52:55], v15, s[24:27], s55 offen offset:0 sc1
  s_add_u32 s54, s54, 20480
  s_add_u32 s55, s55, 20480
  buffer_load_dwordx4 v[56:59], v15, s[24:27], s56 offen sc1
  s_add_u32 s56, s56, 4096
  buffer_load_dwordx4 v[60:63], v15, s[24:27], s57 offen sc1
  s_add_u32 s57, s57, 4096
  buffer_load_dwordx4 v[64:67], v15, s[24:27], s58 offen sc1
  s_add_u32 s58, s58, 4096
  buffer_load_dwordx4 v[68:71], v15, s[24:27], s59 offen sc1
  s_add_u32 s59, s59, 4096
  buffer_load_dwordx4 v[72:75], v15, s[24:27], s54 offen offset:0 sc1
  buffer_load_dwordx4 v[76:79], v15, s[24:27], s54 offen offset:1024 sc1
  buffer_load_dwordx4 v[80:83], v15, s[24:27], s54 offen offset:2048 sc1
  buffer_load_dwordx4 v[84:87], v15, s[24:27], s54 offen offset:3072 sc1
  buffer_load_dwordx4 v[88:91], v15, s[24:27], s55 offen offset:0 sc1
  s_add_u32 s54, s54, 20480
  s_add_u32 s55, s55, 20480
  buffer_load_dwordx4 v[92:95], v15, s[24:27], s56 offen sc1
  s_add_u32 s56, s56, 4096
  buffer_load_dwordx4 v[96:99], v15, s[24:27], s57 offen sc1
  s_add_u32 s57, s57, 4096
  buffer_load_dwordx4 v[100:103], v15, s[24:27], s58 offen sc1
  s_add_u32 s58, s58, 4096
  buffer_load_dwordx4 v[104:107], v15, s[24:27], s59 offen sc1
  s_add_u32 s59, s59, 4096
  buffer_load_dwordx4 v[108:111], v15, s[24:27], s54 offen offset:0 sc1
  buffer_load_dwordx4 v[112:115], v15, s[24:27], s54 offen offset:1024 sc1
  buffer_load_dwordx4 v[116:119], v15, s[24:27], s54 offen offset:2048 sc1
  buffer_load_dwordx4 v[120:123], v15, s[24:27], s54 offen offset:3072 sc1
  buffer_load_dwordx4 v[124:127], v15, s[24:27], s55 offen offset:0 sc1
  s_add_u32 s54, s54, 20480
  s_add_u32 s55, s55, 20480
  s_mov_b32 s60, s48
  s_mov_b32 s61, s49
  s_mov_b32 s62, 2621440
  s_mov_b32 s63, 0x00020000
  s_mov_b32 s8, s22
  s_mov_b32 s9, s23
  s_mov_b32 s10, 2621440
  s_mov_b32 s11, 0x00020000
  s_lshl_b32 s38, s3, 4
  s_lshl_b32 s39, s4, 6
  s_add_u32 s38, s38, s39
  v_and_b32 v5, 15, v1
  v_lshlrev_b32 v6, 2, v5
  v_add_u32 v5, s38, v5
  s_lshl_b32 s38, s38, 2
  s_add_u32 s38, s38, 8192
  v_mul_u32_u24 v5, 1280, v5
  v_lshrrev_b32 v7, 4, v1
  v_mul_u32_u24 v7, 40, v7
  v_add_u32 v5, v5, v7
  s_mul_i32 s41, s5, 160
  v_add_u32 v208, s41, v5
  buffer_load_dwordx4 v[210:213], v208, s[60:63], 0 offen
  buffer_load_dwordx4 v[214:217], v208, s[60:63], 0 offen offset:16
  buffer_load_dwordx2 v[218:219], v208, s[60:63], 0 offen offset:32
  buffer_load_dword v220, v6, s[24:27], s38 offen sc1
  s_add_u32 s39, s3, 1
  s_and_b32 s39, s39, 3
  s_mul_i32 s39, s39, 15360
  s_add_u32 s39, s39, 1024
  v_add_u32 v223, s39, v15
  s_add_u32 s39, s3, 2
  s_and_b32 s39, s39, 3
  s_mul_i32 s39, s39, 15360
  s_add_u32 s39, s39, 6144
  v_add_u32 v224, s39, v15
  s_add_u32 s39, s3, 3
  s_and_b32 s39, s39, 3
  s_mul_i32 s39, s39, 15360
  s_add_u32 s39, s39, 11264
  v_add_u32 v225, s39, v15
  s_mul_i32 s39, s3, 15360
  s_add_u32 s39, s39, 1024
  v_add_u32 v222, s39, v15
  s_waitcnt vmcnt(22)
  v_mfma_f32_16x16x32_bf16 v[128:131], v[36:39], v[20:23], 0
  v_mfma_f32_16x16x32_bf16 v[132:135], v[40:43], v[20:23], 0
  v_mfma_f32_16x16x32_bf16 v[136:139], v[44:47], v[20:23], 0
  v_mfma_f32_16x16x32_bf16 v[140:143], v[48:51], v[20:23], 0
  v_mfma_f32_16x16x32_bf16 v[144:147], v[52:55], v[20:23], 0
  buffer_load_dwordx4 v[20:23], v15, s[24:27], s56 offen sc1
  s_add_u32 s56, s56, 4096
  v_mfma_f32_16x16x32_bf16 v[148:151], v[36:39], v[24:27], 0
  v_mfma_f32_16x16x32_bf16 v[152:155], v[40:43], v[24:27], 0
  v_mfma_f32_16x16x32_bf16 v[156:159], v[44:47], v[24:27], 0
  v_mfma_f32_16x16x32_bf16 v[160:163], v[48:51], v[24:27], 0
  v_mfma_f32_16x16x32_bf16 v[164:167], v[52:55], v[24:27], 0
  buffer_load_dwordx4 v[24:27], v15, s[24:27], s57 offen sc1
  s_add_u32 s57, s57, 4096
  v_mfma_f32_16x16x32_bf16 v[168:171], v[36:39], v[28:31], 0
  v_mfma_f32_16x16x32_bf16 v[172:175], v[40:43], v[28:31], 0
  v_mfma_f32_16x16x32_bf16 v[176:179], v[44:47], v[28:31], 0
  v_mfma_f32_16x16x32_bf16 v[180:183], v[48:51], v[28:31], 0
  v_mfma_f32_16x16x32_bf16 v[184:187], v[52:55], v[28:31], 0
  buffer_load_dwordx4 v[28:31], v15, s[24:27], s58 offen sc1
  s_add_u32 s58, s58, 4096
  v_mfma_f32_16x16x32_bf16 v[188:191], v[36:39], v[32:35], 0
  buffer_load_dwordx4 v[36:39], v15, s[24:27], s54 offen offset:0 sc1
  v_mfma_f32_16x16x32_bf16 v[192:195], v[40:43], v[32:35], 0
  buffer_load_dwordx4 v[40:43], v15, s[24:27], s54 offen offset:1024 sc1
  v_mfma_f32_16x16x32_bf16 v[196:199], v[44:47], v[32:35], 0
  buffer_load_dwordx4 v[44:47], v15, s[24:27], s54 offen offset:2048 sc1
  v_mfma_f32_16x16x32_bf16 v[200:203], v[48:51], v[32:35], 0
  buffer_load_dwordx4 v[48:51], v15, s[24:27], s54 offen offset:3072 sc1
  v_mfma_f32_16x16x32_bf16 v[204:207], v[52:55], v[32:35], 0
  buffer_load_dwordx4 v[52:55], v15, s[24:27], s55 offen offset:0 sc1
  s_add_u32 s54, s54, 20480
  s_add_u32 s55, s55, 20480
  buffer_load_dwordx4 v[32:35], v15, s[24:27], s59 offen sc1
  s_add_u32 s59, s59, 4096
  s_waitcnt vmcnt(22)
  v_mfma_f32_16x16x32_bf16 v[128:131], v[72:75], v[56:59], v[128:131]
  v_mfma_f32_16x16x32_bf16 v[132:135], v[76:79], v[56:59], v[132:135]
  v_mfma_f32_16x16x32_bf16 v[136:139], v[80:83], v[56:59], v[136:139]
  v_mfma_f32_16x16x32_bf16 v[140:143], v[84:87], v[56:59], v[140:143]
  v_mfma_f32_16x16x32_bf16 v[144:147], v[88:91], v[56:59], v[144:147]
  buffer_load_dwordx4 v[56:59], v15, s[24:27], s56 offen sc1
  s_add_u32 s56, s56, 4096
  v_mfma_f32_16x16x32_bf16 v[148:151], v[72:75], v[60:63], v[148:151]
  v_mfma_f32_16x16x32_bf16 v[152:155], v[76:79], v[60:63], v[152:155]
  v_mfma_f32_16x16x32_bf16 v[156:159], v[80:83], v[60:63], v[156:159]
  v_mfma_f32_16x16x32_bf16 v[160:163], v[84:87], v[60:63], v[160:163]
  v_mfma_f32_16x16x32_bf16 v[164:167], v[88:91], v[60:63], v[164:167]
  buffer_load_dwordx4 v[60:63], v15, s[24:27], s57 offen sc1
  s_add_u32 s57, s57, 4096
  v_mfma_f32_16x16x32_bf16 v[168:171], v[72:75], v[64:67], v[168:171]
  v_mfma_f32_16x16x32_bf16 v[172:175], v[76:79], v[64:67], v[172:175]
  v_mfma_f32_16x16x32_bf16 v[176:179], v[80:83], v[64:67], v[176:179]
  v_mfma_f32_16x16x32_bf16 v[180:183], v[84:87], v[64:67], v[180:183]
  v_mfma_f32_16x16x32_bf16 v[184:187], v[88:91], v[64:67], v[184:187]
  buffer_load_dwordx4 v[64:67], v15, s[24:27], s58 offen sc1
  s_add_u32 s58, s58, 4096
  v_mfma_f32_16x16x32_bf16 v[188:191], v[72:75], v[68:71], v[188:191]
  buffer_load_dwordx4 v[72:75], v15, s[24:27], s54 offen offset:0 sc1
  v_mfma_f32_16x16x32_bf16 v[192:195], v[76:79], v[68:71], v[192:195]
  buffer_load_dwordx4 v[76:79], v15, s[24:27], s54 offen offset:1024 sc1
  v_mfma_f32_16x16x32_bf16 v[196:199], v[80:83], v[68:71], v[196:199]
  buffer_load_dwordx4 v[80:83], v15, s[24:27], s54 offen offset:2048 sc1
  v_mfma_f32_16x16x32_bf16 v[200:203], v[84:87], v[68:71], v[200:203]
  buffer_load_dwordx4 v[84:87], v15, s[24:27], s54 offen offset:3072 sc1
  v_mfma_f32_16x16x32_bf16 v[204:207], v[88:91], v[68:71], v[204:207]
  buffer_load_dwordx4 v[88:91], v15, s[24:27], s55 offen offset:0 sc1
  s_add_u32 s54, s54, 20480
  s_add_u32 s55, s55, 20480
  buffer_load_dwordx4 v[68:71], v15, s[24:27], s59 offen sc1
  s_add_u32 s59, s59, 4096
  s_waitcnt vmcnt(22)
  v_mfma_f32_16x16x32_bf16 v[128:131], v[108:111], v[92:95], v[128:131]
  v_mfma_f32_16x16x32_bf16 v[132:135], v[112:115], v[92:95], v[132:135]
  v_mfma_f32_16x16x32_bf16 v[136:139], v[116:119], v[92:95], v[136:139]
  v_mfma_f32_16x16x32_bf16 v[140:143], v[120:123], v[92:95], v[140:143]
  v_mfma_f32_16x16x32_bf16 v[144:147], v[124:127], v[92:95], v[144:147]
  buffer_load_dwordx4 v[92:95], v15, s[24:27], s56 offen sc1
  s_add_u32 s56, s56, 4096
  v_mfma_f32_16x16x32_bf16 v[148:151], v[108:111], v[96:99], v[148:151]
  v_mfma_f32_16x16x32_bf16 v[152:155], v[112:115], v[96:99], v[152:155]
  v_mfma_f32_16x16x32_bf16 v[156:159], v[116:119], v[96:99], v[156:159]
  v_mfma_f32_16x16x32_bf16 v[160:163], v[120:123], v[96:99], v[160:163]
  v_mfma_f32_16x16x32_bf16 v[164:167], v[124:127], v[96:99], v[164:167]
  buffer_load_dwordx4 v[96:99], v15, s[24:27], s57 offen sc1
  s_add_u32 s57, s57, 4096
  v_mfma_f32_16x16x32_bf16 v[168:171], v[108:111], v[100:103], v[168:171]
  v_mfma_f32_16x16x32_bf16 v[172:175], v[112:115], v[100:103], v[172:175]
  v_mfma_f32_16x16x32_bf16 v[176:179], v[116:119], v[100:103], v[176:179]
  v_mfma_f32_16x16x32_bf16 v[180:183], v[120:123], v[100:103], v[180:183]
  v_mfma_f32_16x16x32_bf16 v[184:187], v[124:127], v[100:103], v[184:187]
  buffer_load_dwordx4 v[100:103], v15, s[24:27], s58 offen sc1
  s_add_u32 s58, s58, 4096
  v_mfma_f32_16x16x32_bf16 v[188:191], v[108:111], v[104:107], v[188:191]
  buffer_load_dwordx4 v[108:111], v15, s[24:27], s54 offen offset:0 sc1
  v_mfma_f32_16x16x32_bf16 v[192:195], v[112:115], v[104:107], v[192:195]
  buffer_load_dwordx4 v[112:115], v15, s[24:27], s54 offen offset:1024 sc1
  v_mfma_f32_16x16x32_bf16 v[196:199], v[116:119], v[104:107], v[196:199]
  buffer_load_dwordx4 v[116:119], v15, s[24:27], s54 offen offset:2048 sc1
  v_mfma_f32_16x16x32_bf16 v[200:203], v[120:123], v[104:107], v[200:203]
  buffer_load_dwordx4 v[120:123], v15, s[24:27], s54 offen offset:3072 sc1
  v_mfma_f32_16x16x32_bf16 v[204:207], v[124:127], v[104:107], v[204:207]
  buffer_load_dwordx4 v[124:127], v15, s[24:27], s55 offen offset:0 sc1
  s_add_u32 s54, s54, 20480
  s_add_u32 s55, s55, 20480
  buffer_load_dwordx4 v[104:107], v15, s[24:27], s59 offen sc1
  s_add_u32 s59, s59, 4096
  s_waitcnt vmcnt(18)
  v_mfma_f32_16x16x32_bf16 v[128:131], v[36:39], v[20:23], v[128:131]
  v_mfma_f32_16x16x32_bf16 v[132:135], v[40:43], v[20:23], v[132:135]
  v_mfma_f32_16x16x32_bf16 v[136:139], v[44:47], v[20:23], v[136:139]
  v_mfma_f32_16x16x32_bf16 v[140:143], v[48:51], v[20:23], v[140:143]
  v_mfma_f32_16x16x32_bf16 v[144:147], v[52:55], v[20:23], v[144:147]
  buffer_load_dwordx4 v[20:23], v15, s[24:27], s56 offen sc1
  s_add_u32 s56, s56, 4096
  v_mfma_f32_16x16x32_bf16 v[148:151], v[36:39], v[24:27], v[148:151]
  v_mfma_f32_16x16x32_bf16 v[152:155], v[40:43], v[24:27], v[152:155]
  v_mfma_f32_16x16x32_bf16 v[156:159], v[44:47], v[24:27], v[156:159]
  v_mfma_f32_16x16x32_bf16 v[160:163], v[48:51], v[24:27], v[160:163]
  v_mfma_f32_16x16x32_bf16 v[164:167], v[52:55], v[24:27], v[164:167]
  buffer_load_dwordx4 v[24:27], v15, s[24:27], s57 offen sc1
  s_add_u32 s57, s57, 4096
  v_mfma_f32_16x16x32_bf16 v[168:171], v[36:39], v[28:31], v[168:171]
  v_mfma_f32_16x16x32_bf16 v[172:175], v[40:43], v[28:31], v[172:175]
  v_mfma_f32_16x16x32_bf16 v[176:179], v[44:47], v[28:31], v[176:179]
  v_mfma_f32_16x16x32_bf16 v[180:183], v[48:51], v[28:31], v[180:183]
  v_mfma_f32_16x16x32_bf16 v[184:187], v[52:55], v[28:31], v[184:187]
  buffer_load_dwordx4 v[28:31], v15, s[24:27], s58 offen sc1
  s_add_u32 s58, s58, 4096
  v_mfma_f32_16x16x32_bf16 v[188:191], v[36:39], v[32:35], v[188:191]
  buffer_load_dwordx4 v[36:39], v15, s[24:27], s54 offen offset:0 sc1
  v_mfma_f32_16x16x32_bf16 v[192:195], v[40:43], v[32:35], v[192:195]
  buffer_load_dwordx4 v[40:43], v15, s[24:27], s54 offen offset:1024 sc1
  v_mfma_f32_16x16x32_bf16 v[196:199], v[44:47], v[32:35], v[196:199]
  buffer_load_dwordx4 v[44:47], v15, s[24:27], s54 offen offset:2048 sc1
  v_mfma_f32_16x16x32_bf16 v[200:203], v[48:51], v[32:35], v[200:203]
  buffer_load_dwordx4 v[48:51], v15, s[24:27], s54 offen offset:3072 sc1
  v_mfma_f32_16x16x32_bf16 v[204:207], v[52:55], v[32:35], v[204:207]
  buffer_load_dwordx4 v[52:55], v15, s[24:27], s55 offen offset:0 sc1
  s_add_u32 s54, s54, 20480
  s_add_u32 s55, s55, 20480
  buffer_load_dwordx4 v[32:35], v15, s[24:27], s59 offen sc1
  s_add_u32 s59, s59, 4096
  s_waitcnt vmcnt(18)
  v_mfma_f32_16x16x32_bf16 v[128:131], v[72:75], v[56:59], v[128:131]
  v_mfma_f32_16x16x32_bf16 v[132:135], v[76:79], v[56:59], v[132:135]
  v_mfma_f32_16x16x32_bf16 v[136:139], v[80:83], v[56:59], v[136:139]
  v_mfma_f32_16x16x32_bf16 v[140:143], v[84:87], v[56:59], v[140:143]
  v_mfma_f32_16x16x32_bf16 v[144:147], v[88:91], v[56:59], v[144:147]
  buffer_load_dwordx4 v[56:59], v15, s[24:27], s56 offen sc1
  s_add_u32 s56, s56, 4096
  v_mfma_f32_16x16x32_bf16 v[148:151], v[72:75], v[60:63], v[148:151]
  v_mfma_f32_16x16x32_bf16 v[152:155], v[76:79], v[60:63], v[152:155]
  v_mfma_f32_16x16x32_bf16 v[156:159], v[80:83], v[60:63], v[156:159]
  v_mfma_f32_16x16x32_bf16 v[160:163], v[84:87], v[60:63], v[160:163]
  v_mfma_f32_16x16x32_bf16 v[164:167], v[88:91], v[60:63], v[164:167]
  buffer_load_dwordx4 v[60:63], v15, s[24:27], s57 offen sc1
  s_add_u32 s57, s57, 4096
  v_mfma_f32_16x16x32_bf16 v[168:171], v[72:75], v[64:67], v[168:171]
  v_mfma_f32_16x16x32_bf16 v[172:175], v[76:79], v[64:67], v[172:175]
  v_mfma_f32_16x16x32_bf16 v[176:179], v[80:83], v[64:67], v[176:179]
  v_mfma_f32_16x16x32_bf16 v[180:183], v[84:87], v[64:67], v[180:183]
  v_mfma_f32_16x16x32_bf16 v[184:187], v[88:91], v[64:67], v[184:187]
  buffer_load_dwordx4 v[64:67], v15, s[24:27], s58 offen sc1
  s_add_u32 s58, s58, 4096
  v_mfma_f32_16x16x32_bf16 v[188:191], v[72:75], v[68:71], v[188:191]
  buffer_load_dwordx4 v[72:75], v15, s[24:27], s54 offen offset:0 sc1
  v_mfma_f32_16x16x32_bf16 v[192:195], v[76:79], v[68:71], v[192:195]
  buffer_load_dwordx4 v[76:79], v15, s[24:27], s54 offen offset:1024 sc1
  v_mfma_f32_16x16x32_bf16 v[196:199], v[80:83], v[68:71], v[196:199]
  buffer_load_dwordx4 v[80:83], v15, s[24:27], s54 offen offset:2048 sc1
  v_mfma_f32_16x16x32_bf16 v[200:203], v[84:87], v[68:71], v[200:203]
  buffer_load_dwordx4 v[84:87], v15, s[24:27], s54 offen offset:3072 sc1
  v_mfma_f32_16x16x32_bf16 v[204:207], v[88:91], v[68:71], v[204:207]
  buffer_load_dwordx4 v[88:91], v15, s[24:27], s55 offen offset:0 sc1
  s_add_u32 s54, s54, 20480
  s_add_u32 s55, s55, 20480
  buffer_load_dwordx4 v[68:71], v15, s[24:27], s59 offen sc1
  s_add_u32 s59, s59, 4096
  s_waitcnt vmcnt(18)
  v_mfma_f32_16x16x32_bf16 v[128:131], v[108:111], v[92:95], v[128:131]
  v_mfma_f32_16x16x32_bf16 v[132:135], v[112:115], v[92:95], v[132:135]
  v_mfma_f32_16x16x32_bf16 v[136:139], v[116:119], v[92:95], v[136:139]
  v_mfma_f32_16x16x32_bf16 v[140:143], v[120:123], v[92:95], v[140:143]
  v_mfma_f32_16x16x32_bf16 v[144:147], v[124:127], v[92:95], v[144:147]
  buffer_load_dwordx4 v[92:95], v15, s[24:27], s56 offen sc1
  s_add_u32 s56, s56, 4096
  v_mfma_f32_16x16x32_bf16 v[148:151], v[108:111], v[96:99], v[148:151]
  v_mfma_f32_16x16x32_bf16 v[152:155], v[112:115], v[96:99], v[152:155]
  v_mfma_f32_16x16x32_bf16 v[156:159], v[116:119], v[96:99], v[156:159]
  v_mfma_f32_16x16x32_bf16 v[160:163], v[120:123], v[96:99], v[160:163]
  v_mfma_f32_16x16x32_bf16 v[164:167], v[124:127], v[96:99], v[164:167]
  buffer_load_dwordx4 v[96:99], v15, s[24:27], s57 offen sc1
  s_add_u32 s57, s57, 4096
  v_mfma_f32_16x16x32_bf16 v[168:171], v[108:111], v[100:103], v[168:171]
  v_mfma_f32_16x16x32_bf16 v[172:175], v[112:115], v[100:103], v[172:175]
  v_mfma_f32_16x16x32_bf16 v[176:179], v[116:119], v[100:103], v[176:179]
  v_mfma_f32_16x16x32_bf16 v[180:183], v[120:123], v[100:103], v[180:183]
  v_mfma_f32_16x16x32_bf16 v[184:187], v[124:127], v[100:103], v[184:187]
  buffer_load_dwordx4 v[100:103], v15, s[24:27], s58 offen sc1
  s_add_u32 s58, s58, 4096
  v_mfma_f32_16x16x32_bf16 v[188:191], v[108:111], v[104:107], v[188:191]
  buffer_load_dwordx4 v[108:111], v15, s[24:27], s54 offen offset:0 sc1
  v_mfma_f32_16x16x32_bf16 v[192:195], v[112:115], v[104:107], v[192:195]
  buffer_load_dwordx4 v[112:115], v15, s[24:27], s54 offen offset:1024 sc1
  v_mfma_f32_16x16x32_bf16 v[196:199], v[116:119], v[104:107], v[196:199]
  buffer_load_dwordx4 v[116:119], v15, s[24:27], s54 offen offset:2048 sc1
  v_mfma_f32_16x16x32_bf16 v[200:203], v[120:123], v[104:107], v[200:203]
  buffer_load_dwordx4 v[120:123], v15, s[24:27], s54 offen offset:3072 sc1
  v_mfma_f32_16x16x32_bf16 v[204:207], v[124:127], v[104:107], v[204:207]
  buffer_load_dwordx4 v[124:127], v15, s[24:27], s55 offen offset:0 sc1
  s_add_u32 s54, s54, 20480
  s_add_u32 s55, s55, 20480
  buffer_load_dwordx4 v[104:107], v15, s[24:27], s59 offen sc1
  s_add_u32 s59, s59, 4096
  s_waitcnt vmcnt(18)
  v_mfma_f32_16x16x32_bf16 v[128:131], v[36:39], v[20:23], v[128:131]
  v_mfma_f32_16x16x32_bf16 v[132:135], v[40:43], v[20:23], v[132:135]
  v_mfma_f32_16x16x32_bf16 v[136:139], v[44:47], v[20:23], v[136:139]
  v_mfma_f32_16x16x32_bf16 v[140:143], v[48:51], v[20:23], v[140:143]
  v_mfma_f32_16x16x32_bf16 v[144:147], v[52:55], v[20:23], v[144:147]
  buffer_load_dwordx4 v[20:23], v15, s[24:27], s56 offen sc1
  s_add_u32 s56, s56, 4096
  v_mfma_f32_16x16x32_bf16 v[148:151], v[36:39], v[24:27], v[148:151]
  v_mfma_f32_16x16x32_bf16 v[152:155], v[40:43], v[24:27], v[152:155]
  v_mfma_f32_16x16x32_bf16 v[156:159], v[44:47], v[24:27], v[156:159]
  v_mfma_f32_16x16x32_bf16 v[160:163], v[48:51], v[24:27], v[160:163]
  v_mfma_f32_16x16x32_bf16 v[164:167], v[52:55], v[24:27], v[164:167]
  buffer_load_dwordx4 v[24:27], v15, s[24:27], s57 offen sc1
  s_add_u32 s57, s57, 4096
  v_mfma_f32_16x16x32_bf16 v[168:171], v[36:39], v[28:31], v[168:171]
  v_mfma_f32_16x16x32_bf16 v[172:175], v[40:43], v[28:31], v[172:175]
  v_mfma_f32_16x16x32_bf16 v[176:179], v[44:47], v[28:31], v[176:179]
  v_mfma_f32_16x16x32_bf16 v[180:183], v[48:51], v[28:31], v[180:183]
  v_mfma_f32_16x16x32_bf16 v[184:187], v[52:55], v[28:31], v[184:187]
  buffer_load_dwordx4 v[28:31], v15, s[24:27], s58 offen sc1
  s_add_u32 s58, s58, 4096
  v_mfma_f32_16x16x32_bf16 v[188:191], v[36:39], v[32:35], v[188:191]
  buffer_load_dwordx4 v[36:39], v15, s[24:27], s54 offen offset:0 sc1
  v_mfma_f32_16x16x32_bf16 v[192:195], v[40:43], v[32:35], v[192:195]
  buffer_load_dwordx4 v[40:43], v15, s[24:27], s54 offen offset:1024 sc1
  v_mfma_f32_16x16x32_bf16 v[196:199], v[44:47], v[32:35], v[196:199]
  buffer_load_dwordx4 v[44:47], v15, s[24:27], s54 offen offset:2048 sc1
  v_mfma_f32_16x16x32_bf16 v[200:203], v[48:51], v[32:35], v[200:203]
  buffer_load_dwordx4 v[48:51], v15, s[24:27], s54 offen offset:3072 sc1
  v_mfma_f32_16x16x32_bf16 v[204:207], v[52:55], v[32:35], v[204:207]
  buffer_load_dwordx4 v[52:55], v15, s[24:27], s55 offen offset:0 sc1
  s_add_u32 s54, s54, 20480
  s_add_u32 s55, s55, 20480
  buffer_load_dwordx4 v[32:35], v15, s[24:27], s59 offen sc1
  s_add_u32 s59, s59, 4096
  s_waitcnt vmcnt(18)
  v_mfma_f32_16x16x32_bf16 v[128:131], v[72:75], v[56:59], v[128:131]
  v_mfma_f32_16x16x32_bf16 v[132:135], v[76:79], v[56:59], v[132:135]
  v_mfma_f32_16x16x32_bf16 v[136:139], v[80:83], v[56:59], v[136:139]
  v_mfma_f32_16x16x32_bf16 v[140:143], v[84:87], v[56:59], v[140:143]
  v_mfma_f32_16x16x32_bf16 v[144:147], v[88:91], v[56:59], v[144:147]
  buffer_load_dwordx4 v[56:59], v15, s[24:27], s56 offen sc1
  s_add_u32 s56, s56, 4096
  v_mfma_f32_16x16x32_bf16 v[148:151], v[72:75], v[60:63], v[148:151]
  v_mfma_f32_16x16x32_bf16 v[152:155], v[76:79], v[60:63], v[152:155]
  v_mfma_f32_16x16x32_bf16 v[156:159], v[80:83], v[60:63], v[156:159]
  v_mfma_f32_16x16x32_bf16 v[160:163], v[84:87], v[60:63], v[160:163]
  v_mfma_f32_16x16x32_bf16 v[164:167], v[88:91], v[60:63], v[164:167]
  buffer_load_dwordx4 v[60:63], v15, s[24:27], s57 offen sc1
  s_add_u32 s57, s57, 4096
  v_mfma_f32_16x16x32_bf16 v[168:171], v[72:75], v[64:67], v[168:171]
  v_mfma_f32_16x16x32_bf16 v[172:175], v[76:79], v[64:67], v[172:175]
  v_mfma_f32_16x16x32_bf16 v[176:179], v[80:83], v[64:67], v[176:179]
  v_mfma_f32_16x16x32_bf16 v[180:183], v[84:87], v[64:67], v[180:183]
  v_mfma_f32_16x16x32_bf16 v[184:187], v[88:91], v[64:67], v[184:187]
  buffer_load_dwordx4 v[64:67], v15, s[24:27], s58 offen sc1
  s_add_u32 s58, s58, 4096
  v_mfma_f32_16x16x32_bf16 v[188:191], v[72:75], v[68:71], v[188:191]
  buffer_load_dwordx4 v[72:75], v15, s[24:27], s54 offen offset:0 sc1
  v_mfma_f32_16x16x32_bf16 v[192:195], v[76:79], v[68:71], v[192:195]
  buffer_load_dwordx4 v[76:79], v15, s[24:27], s54 offen offset:1024 sc1
  v_mfma_f32_16x16x32_bf16 v[196:199], v[80:83], v[68:71], v[196:199]
  buffer_load_dwordx4 v[80:83], v15, s[24:27], s54 offen offset:2048 sc1
  v_mfma_f32_16x16x32_bf16 v[200:203], v[84:87], v[68:71], v[200:203]
  buffer_load_dwordx4 v[84:87], v15, s[24:27], s54 offen offset:3072 sc1
  v_mfma_f32_16x16x32_bf16 v[204:207], v[88:91], v[68:71], v[204:207]
  buffer_load_dwordx4 v[88:91], v15, s[24:27], s55 offen offset:0 sc1
  s_add_u32 s54, s54, 20480
  s_add_u32 s55, s55, 20480
  buffer_load_dwordx4 v[68:71], v15, s[24:27], s59 offen sc1
  s_add_u32 s59, s59, 4096
  s_waitcnt vmcnt(18)
  v_mfma_f32_16x16x32_bf16 v[128:131], v[108:111], v[92:95], v[128:131]
  v_mfma_f32_16x16x32_bf16 v[132:135], v[112:115], v[92:95], v[132:135]
  v_mfma_f32_16x16x32_bf16 v[136:139], v[116:119], v[92:95], v[136:139]
  v_mfma_f32_16x16x32_bf16 v[140:143], v[120:123], v[92:95], v[140:143]
  v_mfma_f32_16x16x32_bf16 v[144:147], v[124:127], v[92:95], v[144:147]
  buffer_load_dwordx4 v[92:95], v15, s[24:27], s56 offen sc1
  s_sub_u32 s56, s56, 65536
  v_mfma_f32_16x16x32_bf16 v[148:151], v[108:111], v[96:99], v[148:151]
  v_mfma_f32_16x16x32_bf16 v[152:155], v[112:115], v[96:99], v[152:155]
  v_mfma_f32_16x16x32_bf16 v[156:159], v[116:119], v[96:99], v[156:159]
  v_mfma_f32_16x16x32_bf16 v[160:163], v[120:123], v[96:99], v[160:163]
  v_mfma_f32_16x16x32_bf16 v[164:167], v[124:127], v[96:99], v[164:167]
  buffer_load_dwordx4 v[96:99], v15, s[24:27], s57 offen sc1
  s_sub_u32 s57, s57, 65536
  v_mfma_f32_16x16x32_bf16 v[168:171], v[108:111], v[100:103], v[168:171]
  v_mfma_f32_16x16x32_bf16 v[172:175], v[112:115], v[100:103], v[172:175]
  v_mfma_f32_16x16x32_bf16 v[176:179], v[116:119], v[100:103], v[176:179]
  v_mfma_f32_16x16x32_bf16 v[180:183], v[120:123], v[100:103], v[180:183]
  v_mfma_f32_16x16x32_bf16 v[184:187], v[124:127], v[100:103], v[184:187]
  buffer_load_dwordx4 v[100:103], v15, s[24:27], s58 offen sc1
  s_sub_u32 s58, s58, 65536
  v_mfma_f32_16x16x32_bf16 v[188:191], v[108:111], v[104:107], v[188:191]
  buffer_load_dwordx4 v[108:111], v15, s[24:27], s54 offen offset:0 sc1
  v_mfma_f32_16x16x32_bf16 v[192:195], v[112:115], v[104:107], v[192:195]
  buffer_load_dwordx4 v[112:115], v15, s[24:27], s54 offen offset:1024 sc1
  v_mfma_f32_16x16x32_bf16 v[196:199], v[116:119], v[104:107], v[196:199]
  buffer_load_dwordx4 v[116:119], v15, s[24:27], s54 offen offset:2048 sc1
  v_mfma_f32_16x16x32_bf16 v[200:203], v[120:123], v[104:107], v[200:203]
  buffer_load_dwordx4 v[120:123], v15, s[24:27], s54 offen offset:3072 sc1
  v_mfma_f32_16x16x32_bf16 v[204:207], v[124:127], v[104:107], v[204:207]
  buffer_load_dwordx4 v[124:127], v15, s[24:27], s55 offen offset:0 sc1
  s_sub_u32 s54, s54, 327680
  s_sub_u32 s55, s55, 327680
  buffer_load_dwordx4 v[104:107], v15, s[24:27], s59 offen sc1
  s_sub_u32 s59, s59, 65536
  s_waitcnt vmcnt(18)
  v_mfma_f32_16x16x32_bf16 v[128:131], v[36:39], v[20:23], v[128:131]
  v_mfma_f32_16x16x32_bf16 v[132:135], v[40:43], v[20:23], v[132:135]
  v_mfma_f32_16x16x32_bf16 v[136:139], v[44:47], v[20:23], v[136:139]
  v_mfma_f32_16x16x32_bf16 v[140:143], v[48:51], v[20:23], v[140:143]
  v_mfma_f32_16x16x32_bf16 v[144:147], v[52:55], v[20:23], v[144:147]
  v_mfma_f32_16x16x32_bf16 v[148:151], v[36:39], v[24:27], v[148:151]
  v_mfma_f32_16x16x32_bf16 v[152:155], v[40:43], v[24:27], v[152:155]
  v_mfma_f32_16x16x32_bf16 v[156:159], v[44:47], v[24:27], v[156:159]
  v_mfma_f32_16x16x32_bf16 v[160:163], v[48:51], v[24:27], v[160:163]
  v_mfma_f32_16x16x32_bf16 v[164:167], v[52:55], v[24:27], v[164:167]
  v_mfma_f32_16x16x32_bf16 v[168:171], v[36:39], v[28:31], v[168:171]
  v_mfma_f32_16x16x32_bf16 v[172:175], v[40:43], v[28:31], v[172:175]
  v_mfma_f32_16x16x32_bf16 v[176:179], v[44:47], v[28:31], v[176:179]
  v_mfma_f32_16x16x32_bf16 v[180:183], v[48:51], v[28:31], v[180:183]
  v_mfma_f32_16x16x32_bf16 v[184:187], v[52:55], v[28:31], v[184:187]
  v_mfma_f32_16x16x32_bf16 v[188:191], v[36:39], v[32:35], v[188:191]
  buffer_load_dwordx4 v[36:39], v15, s[24:27], s54 offen offset:0 sc1
  v_mfma_f32_16x16x32_bf16 v[192:195], v[40:43], v[32:35], v[192:195]
  buffer_load_dwordx4 v[40:43], v15, s[24:27], s54 offen offset:1024 sc1
  v_mfma_f32_16x16x32_bf16 v[196:199], v[44:47], v[32:35], v[196:199]
  buffer_load_dwordx4 v[44:47], v15, s[24:27], s54 offen offset:2048 sc1
  v_mfma_f32_16x16x32_bf16 v[200:203], v[48:51], v[32:35], v[200:203]
  buffer_load_dwordx4 v[48:51], v15, s[24:27], s54 offen offset:3072 sc1
  v_mfma_f32_16x16x32_bf16 v[204:207], v[52:55], v[32:35], v[204:207]
  buffer_load_dwordx4 v[52:55], v15, s[24:27], s55 offen offset:0 sc1
  s_add_u32 s54, s54, 20480
  s_add_u32 s55, s55, 20480
  s_waitcnt vmcnt(14)
  v_mfma_f32_16x16x32_bf16 v[128:131], v[72:75], v[56:59], v[128:131]
  v_mfma_f32_16x16x32_bf16 v[132:135], v[76:79], v[56:59], v[132:135]
  v_mfma_f32_16x16x32_bf16 v[136:139], v[80:83], v[56:59], v[136:139]
  v_mfma_f32_16x16x32_bf16 v[140:143], v[84:87], v[56:59], v[140:143]
  v_mfma_f32_16x16x32_bf16 v[144:147], v[88:91], v[56:59], v[144:147]
  v_mfma_f32_16x16x32_bf16 v[148:151], v[72:75], v[60:63], v[148:151]
  v_mfma_f32_16x16x32_bf16 v[152:155], v[76:79], v[60:63], v[152:155]
  v_mfma_f32_16x16x32_bf16 v[156:159], v[80:83], v[60:63], v[156:159]
  v_mfma_f32_16x16x32_bf16 v[160:163], v[84:87], v[60:63], v[160:163]
  v_mfma_f32_16x16x32_bf16 v[164:167], v[88:91], v[60:63], v[164:167]
  v_mfma_f32_16x16x32_bf16 v[168:171], v[72:75], v[64:67], v[168:171]
  v_mfma_f32_16x16x32_bf16 v[172:175], v[76:79], v[64:67], v[172:175]
  v_mfma_f32_16x16x32_bf16 v[176:179], v[80:83], v[64:67], v[176:179]
  v_mfma_f32_16x16x32_bf16 v[180:183], v[84:87], v[64:67], v[180:183]
  v_mfma_f32_16x16x32_bf16 v[184:187], v[88:91], v[64:67], v[184:187]
  v_mfma_f32_16x16x32_bf16 v[188:191], v[72:75], v[68:71], v[188:191]
  buffer_load_dwordx4 v[72:75], v15, s[24:27], s54 offen offset:0 sc1
  v_mfma_f32_16x16x32_bf16 v[192:195], v[76:79], v[68:71], v[192:195]
  buffer_load_dwordx4 v[76:79], v15, s[24:27], s54 offen offset:1024 sc1
  v_mfma_f32_16x16x32_bf16 v[196:199], v[80:83], v[68:71], v[196:199]
  buffer_load_dwordx4 v[80:83], v15, s[24:27], s54 offen offset:2048 sc1
  v_mfma_f32_16x16x32_bf16 v[200:203], v[84:87], v[68:71], v[200:203]
  buffer_load_dwordx4 v[84:87], v15, s[24:27], s54 offen offset:3072 sc1
  v_mfma_f32_16x16x32_bf16 v[204:207], v[88:91], v[68:71], v[204:207]
  buffer_load_dwordx4 v[88:91], v15, s[24:27], s55 offen offset:0 sc1
  s_add_u32 s54, s54, 20480
  s_add_u32 s55, s55, 20480
  s_waitcnt vmcnt(10)
  v_mfma_f32_16x16x32_bf16 v[128:131], v[108:111], v[92:95], v[128:131]
  v_mfma_f32_16x16x32_bf16 v[132:135], v[112:115], v[92:95], v[132:135]
  v_mfma_f32_16x16x32_bf16 v[136:139], v[116:119], v[92:95], v[136:139]
  v_mfma_f32_16x16x32_bf16 v[140:143], v[120:123], v[92:95], v[140:143]
  v_mfma_f32_16x16x32_bf16 v[144:147], v[124:127], v[92:95], v[144:147]
  v_mfma_f32_16x16x32_bf16 v[148:151], v[108:111], v[96:99], v[148:151]
  v_mfma_f32_16x16x32_bf16 v[152:155], v[112:115], v[96:99], v[152:155]
  v_mfma_f32_16x16x32_bf16 v[156:159], v[116:119], v[96:99], v[156:159]
  v_mfma_f32_16x16x32_bf16 v[160:163], v[120:123], v[96:99], v[160:163]
  v_mfma_f32_16x16x32_bf16 v[164:167], v[124:127], v[96:99], v[164:167]
  v_mfma_f32_16x16x32_bf16 v[168:171], v[108:111], v[100:103], v[168:171]
  v_mfma_f32_16x16x32_bf16 v[172:175], v[112:115], v[100:103], v[172:175]
  v_mfma_f32_16x16x32_bf16 v[176:179], v[116:119], v[100:103], v[176:179]
  v_mfma_f32_16x16x32_bf16 v[180:183], v[120:123], v[100:103], v[180:183]
  v_mfma_f32_16x16x32_bf16 v[184:187], v[124:127], v[100:103], v[184:187]
  v_mfma_f32_16x16x32_bf16 v[188:191], v[108:111], v[104:107], v[188:191]
  buffer_load_dwordx4 v[108:111], v15, s[24:27], s54 offen offset:0 sc1
  v_mfma_f32_16x16x32_bf16 v[192:195], v[112:115], v[104:107], v[192:195]
  buffer_load_dwordx4 v[112:115], v15, s[24:27], s54 offen offset:1024 sc1
  v_mfma_f32_16x16x32_bf16 v[196:199], v[116:119], v[104:107], v[196:199]
  buffer_load_dwordx4 v[116:119], v15, s[24:27], s54 offen offset:2048 sc1
  v_mfma_f32_16x16x32_bf16 v[200:203], v[120:123], v[104:107], v[200:203]
  buffer_load_dwordx4 v[120:123], v15, s[24:27], s54 offen offset:3072 sc1
  v_mfma_f32_16x16x32_bf16 v[204:207], v[124:127], v[104:107], v[204:207]
  buffer_load_dwordx4 v[124:127], v15, s[24:27], s55 offen offset:0 sc1
  s_add_u32 s54, s54, 20480
  s_add_u32 s55, s55, 20480
  s_lshr_b32 s36, s4, 2
  s_lshl_b32 s36, s36, 12
  s_add_u32 s36, s36, 65536
  v_mov_b32 v5, 0
  v_and_b32 v8, 31, v1
  v_lshlrev_b32 v8, 7, v8
  s_movk_i32 s37, 400
  s_cmp_eq_u32 s3, 0
  s_cselect_b32 s40, 16, 20
  s_cselect_b32 s41, 4, 1
  v_mov_b32 v9, s40
L3_lw:
  ds_read_b32 v7, v9 offset:0
  s_waitcnt lgkmcnt(0)
  v_readfirstlane_b32 s39, v7
  s_nop 1
  s_cmp_ge_u32 s39, s41
  s_cbranch_scc1 L3_lok
  s_sleep 1
  s_branch L3_lw
L3_lok:
  s_cmp_eq_u32 s3, 0
  s_cbranch_scc1 L3_poll
  s_cmp_eq_u32 s39, 1
  s_cbranch_scc1 L3_pok
  s_branch L3_fb
L3_poll:
  buffer_load_dword v6, v8, s[24:27], s36 offen sc1
  s_waitcnt vmcnt(0)
  v_cmp_ne_u32 vcc, s90, v6
  v_mov_b32 v7, 1
  s_nop 3
  s_cbranch_vccz L3_verdict
  s_sub_u32 s37, s37, 1
  v_mov_b32 v7, 2
  s_cmp_le_i32 s37, 0
  s_cbranch_scc1 L3_verdict
  s_sleep 1
  s_branch L3_poll
L3_verdict:
  ds_write_b32 v5, v7 offset:20
  s_cbranch_vccz L3_pok
L3_fb:
  s_waitcnt vmcnt(0) lgkmcnt(0)
  s_mov_b32 s46, 2
  s_mov_b32 s47, 0
  v_bfe_u32 v2, v1, 4, 1
  v_mul_u32_u24 v2, 70656, v2
  v_and_b32 v3, 15, v1
  v_lshl_add_u32 v2, v3, 4, v2
  v_lshrrev_b32 v3, 5, v1
  v_lshl_add_u32 v3, v3, 8, v2
  v_mov_b32 v9, 0x3f803f80
  v_cndmask_b32 v40, 0, v9, s[44:45]
  v_cndmask_b32 v41, 0, v9, s[44:45]
  v_cndmask_b32 v42, 0, v9, s[44:45]
  v_cndmask_b32 v43, 0, v9, s[44:45]
  v_cndmask_b32 v44, 0, v9, s[44:45]
  v_cndmask_b32 v45, 0, v9, s[44:45]
  v_cndmask_b32 v46, 0, v9, s[44:45]
  v_cndmask_b32 v47, 0, v9, s[44:45]
L3_fb_unit:
  s_lshr_b32 s28, s47, 1
  s_and_b32 s35, s47, 1
  s_lshl_b32 s36, s4, 1
  s_add_u32 s35, s35, s36
  s_lshl_b32 s38, s28, 6
  s_add_u32 s38, s38, s35
  s_mul_i32 s38, s38, 1280
  s_add_u32 s38, s38, 2621440
  v_and_b32 v5, 31, v1
  v_lshrrev_b32 v6, 5, v1
  v_lshlrev_b32 v7, 3, v5
  v_add_u32 v7, 1024, v7
  v_lshlrev_b32 v8, 30, v6
  v_add_u32 v8, v8, v7
  buffer_load_dwordx4 v[16:19], v15, s[24:27], s38 offen sc1
  buffer_load_dwordx2 v[20:21], v8, s[24:27], s38 offen sc1
  s_lshl_b32 s37, s35, 7
  s_add_u32 s37, s37, 8192
  v_lshlrev_b32 v9, 2, v5
  buffer_load_dword v13, v9, s[24:27], s37 offen sc1
  s_branch L2_slow
L3_fb_next:
  s_add_u32 s47, s47, 1
  s_cmp_lt_u32 s47, 64
  s_cbranch_scc1 L3_fb_unit
  s_waitcnt vmcnt(0)
  s_sub_u32 s54, s54, 61440
  s_sub_u32 s55, s55, 61440
  buffer_load_dwordx4 v[36:39], v15, s[24:27], s54 offen offset:0 sc1
  buffer_load_dwordx4 v[40:43], v15, s[24:27], s54 offen offset:1024 sc1
  buffer_load_dwordx4 v[44:47], v15, s[24:27], s54 offen offset:2048 sc1
  buffer_load_dwordx4 v[48:51], v15, s[24:27], s54 offen offset:3072 sc1
  buffer_load_dwordx4 v[52:55], v15, s[24:27], s55 offen offset:0 sc1
  s_add_u32 s54, s54, 20480
  s_add_u32 s55, s55, 20480
  buffer_load_dwordx4 v[72:75], v15, s[24:27], s54 offen offset:0 sc1
  buffer_load_dwordx4 v[76:79], v15, s[24:27], s54 offen offset:1024 sc1
  buffer_load_dwordx4 v[80:83], v15, s[24:27], s54 offen offset:2048 sc1
  buffer_load_dwordx4 v[84:87], v15, s[24:27], s54 offen offset:3072 sc1
  buffer_load_dwordx4 v[88:91], v15, s[24:27], s55 offen offset:0 sc1
  s_add_u32 s54, s54, 20480
  s_add_u32 s55, s55, 20480
  buffer_load_dwordx4 v[108:111], v15, s[24:27], s54 offen offset:0 sc1
  buffer_load_dwordx4 v[112:115], v15, s[24:27], s54 offen offset:1024 sc1
  buffer_load_dwordx4 v[116:119], v15, s[24:27], s54 offen offset:2048 sc1
  buffer_load_dwordx4 v[120:123], v15, s[24:27], s54 offen offset:3072 sc1
  buffer_load_dwordx4 v[124:127], v15, s[24:27], s55 offen offset:0 sc1
  s_add_u32 s54, s54, 20480
  s_add_u32 s55, s55, 20480
L3_pok:
  buffer_load_dwordx4 v[20:23], v15, s[24:27], s56 offen sc1
  s_add_u32 s56, s56, 4096
  buffer_load_dwordx4 v[24:27], v15, s[24:27], s57 offen sc1
  s_add_u32 s57, s57, 4096
  buffer_load_dwordx4 v[28:31], v15, s[24:27], s58 offen sc1
  s_add_u32 s58, s58, 4096
  buffer_load_dwordx4 v[32:35], v15, s[24:27], s59 offen sc1
  s_add_u32 s59, s59, 4096
  buffer_load_dwordx4 v[56:59], v15, s[24:27], s56 offen sc1
  s_add_u32 s56, s56, 4096
  buffer_load_dwordx4 v[60:63], v15, s[24:27], s57 offen sc1
  s_add_u32 s57, s57, 4096
  buffer_load_dwordx4 v[64:67], v15, s[24:27], s58 offen sc1
  s_add_u32 s58, s58, 4096
  buffer_load_dwordx4 v[68:71], v15, s[24:27], s59 offen sc1
  s_add_u32 s59, s59, 4096
  buffer_load_dwordx4 v[92:95], v15, s[24:27], s56 offen sc1
  s_add_u32 s56, s56, 4096
  buffer_load_dwordx4 v[96:99], v15, s[24:27], s57 offen sc1
  s_add_u32 s57, s57, 4096
  buffer_load_dwordx4 v[100:103], v15, s[24:27], s58 offen sc1
  s_add_u32 s58, s58, 4096
  buffer_load_dwordx4 v[104:107], v15, s[24:27], s59 offen sc1
  s_add_u32 s59, s59, 4096
  buffer_load_dwordx4 v[228:231], v15, s[24:27], s56 offen sc1
  s_add_u32 s56, s56, 4096
  buffer_load_dwordx4 v[232:235], v15, s[24:27], s57 offen sc1
  s_add_u32 s57, s57, 4096
  buffer_load_dwordx4 v[236:239], v15, s[24:27], s58 offen sc1
  s_add_u32 s58, s58, 4096
  buffer_load_dwordx4 v[240:243], v15, s[24:27], s59 offen sc1
  s_add_u32 s59, s59, 4096
  buffer_load_dwordx4 v[244:247], v15, s[24:27], s56 offen sc1
  s_add_u32 s56, s56, 4096
  buffer_load_dwordx4 v[248:251], v15, s[24:27], s57 offen sc1
  s_add_u32 s57, s57, 4096
  buffer_load_dwordx4 v[252:255], v15, s[24:27], s58 offen sc1
  s_add_u32 s58, s58, 4096
  buffer_load_dwordx4 v[4:7], v15, s[24:27], s59 offen sc1
  s_add_u32 s59, s59, 4096
  s_waitcnt vmcnt(16)
  v_mfma_f32_16x16x32_bf16 v[128:131], v[36:39], v[20:23], v[128:131]
  v_mfma_f32_16x16x32_bf16 v[132:135], v[40:43], v[20:23], v[132:135]
  v_mfma_f32_16x16x32_bf16 v[136:139], v[44:47], v[20:23], v[136:139]
  v_mfma_f32_16x16x32_bf16 v[140:143], v[48:51], v[20:23], v[140:143]
  v_mfma_f32_16x16x32_bf16 v[144:147], v[52:55], v[20:23], v[144:147]
  v_mfma_f32_16x16x32_bf16 v[148:151], v[36:39], v[24:27], v[148:151]
  v_mfma_f32_16x16x32_bf16 v[152:155], v[40:43], v[24:27], v[152:155]
  v_mfma_f32_16x16x32_bf16 v[156:159], v[44:47], v[24:27], v[156:159]
  v_mfma_f32_16x16x32_bf16 v[160:163], v[48:51], v[24:27], v[160:163]
  v_mfma_f32_16x16x32_bf16 v[164:167], v[52:55], v[24:27], v[164:167]
  v_mfma_f32_16x16x32_bf16 v[168:171], v[36:39], v[28:31], v[168:171]
  v_mfma_f32_16x16x32_bf16 v[172:175], v[40:43], v[28:31], v[172:175]
  v_mfma_f32_16x16x32_bf16 v[176:179], v[44:47], v[28:31], v[176:179]
  v_mfma_f32_16x16x32_bf16 v[180:183], v[48:51], v[28:31], v[180:183]
  v_mfma_f32_16x16x32_bf16 v[184:187], v[52:55], v[28:31], v[184:187]
  v_mfma_f32_16x16x32_bf16 v[188:191], v[36:39], v[32:35], v[188:191]
  buffer_load_dwordx4 v[36:39], v15, s[24:27], s54 offen offset:0 sc1
  v_mfma_f32_16x16x32_bf16 v[192:195], v[40:43], v[32:35], v[192:195]
  buffer_load_dwordx4 v[40:43], v15, s[24:27], s54 offen offset:1024 sc1
  v_mfma_f32_16x16x32_bf16 v[196:199], v[44:47], v[32:35], v[196:199]
  buffer_load_dwordx4 v[44:47], v15, s[24:27], s54 offen offset:2048 sc1
  v_mfma_f32_16x16x32_bf16 v[200:203], v[48:51], v[32:35], v[200:203]
  buffer_load_dwordx4 v[48:51], v15, s[24:27], s54 offen offset:3072 sc1
  v_mfma_f32_16x16x32_bf16 v[204:207], v[52:55], v[32:35], v[204:207]
  buffer_load_dwordx4 v[52:55], v15, s[24:27], s55 offen offset:0 sc1
  s_add_u32 s54, s54, 20480
  s_add_u32 s55, s55, 20480
  s_waitcnt vmcnt(17)
  v_mfma_f32_16x16x32_bf16 v[128:131], v[72:75], v[56:59], v[128:131]
  v_mfma_f32_16x16x32_bf16 v[132:135], v[76:79], v[56:59], v[132:135]
  v_mfma_f32_16x16x32_bf16 v[136:139], v[80:83], v[56:59], v[136:139]
  v_mfma_f32_16x16x32_bf16 v[140:143], v[84:87], v[56:59], v[140:143]
  v_mfma_f32_16x16x32_bf16 v[144:147], v[88:91], v[56:59], v[144:147]
  v_mfma_f32_16x16x32_bf16 v[148:151], v[72:75], v[60:63], v[148:151]
  v_mfma_f32_16x16x32_bf16 v[152:155], v[76:79], v[60:63], v[152:155]
  v_mfma_f32_16x16x32_bf16 v[156:159], v[80:83], v[60:63], v[156:159]
  v_mfma_f32_16x16x32_bf16 v[160:163], v[84:87], v[60:63], v[160:163]
  v_mfma_f32_16x16x32_bf16 v[164:167], v[88:91], v[60:63], v[164:167]
  v_mfma_f32_16x16x32_bf16 v[168:171], v[72:75], v[64:67], v[168:171]
  v_mfma_f32_16x16x32_bf16 v[172:175], v[76:79], v[64:67], v[172:175]
  v_mfma_f32_16x16x32_bf16 v[176:179], v[80:83], v[64:67], v[176:179]
  v_mfma_f32_16x16x32_bf16 v[180:183], v[84:87], v[64:67], v[180:183]
  v_mfma_f32_16x16x32_bf16 v[184:187], v[88:91], v[64:67], v[184:187]
  v_mfma_f32_16x16x32_bf16 v[188:191], v[72:75], v[68:71], v[188:191]
  buffer_load_dwordx4 v[72:75], v15, s[24:27], s54 offen offset:0 sc1
  v_mfma_f32_16x16x32_bf16 v[192:195], v[76:79], v[68:71], v[192:195]
  buffer_load_dwordx4 v[76:79], v15, s[24:27], s54 offen offset:1024 sc1
  v_mfma_f32_16x16x32_bf16 v[196:199], v[80:83], v[68:71], v[196:199]
  buffer_load_dwordx4 v[80:83], v15, s[24:27], s54 offen offset:2048 sc1
  v_mfma_f32_16x16x32_bf16 v[200:203], v[84:87], v[68:71], v[200:203]
  buffer_load_dwordx4 v[84:87], v15, s[24:27], s54 offen offset:3072 sc1
  v_mfma_f32_16x16x32_bf16 v[204:207], v[88:91], v[68:71], v[204:207]
  buffer_load_dwordx4 v[88:91], v15, s[24:27], s55 offen offset:0 sc1
  s_add_u32 s54, s54, 20480
  s_add_u32 s55, s55, 20480
  s_waitcnt vmcnt(18)
  v_mfma_f32_16x16x32_bf16 v[128:131], v[108:111], v[92:95], v[128:131]
  v_mfma_f32_16x16x32_bf16 v[132:135], v[112:115], v[92:95], v[132:135]
  v_mfma_f32_16x16x32_bf16 v[136:139], v[116:119], v[92:95], v[136:139]
  v_mfma_f32_16x16x32_bf16 v[140:143], v[120:123], v[92:95], v[140:143]
  v_mfma_f32_16x16x32_bf16 v[144:147], v[124:127], v[92:95], v[144:147]
  v_mfma_f32_16x16x32_bf16 v[148:151], v[108:111], v[96:99], v[148:151]
  v_mfma_f32_16x16x32_bf16 v[152:155], v[112:115], v[96:99], v[152:155]
  v_mfma_f32_16x16x32_bf16 v[156:159], v[116:119], v[96:99], v[156:159]
  v_mfma_f32_16x16x32_bf16 v[160:163], v[120:123], v[96:99], v[160:163]
  v_mfma_f32_16x16x32_bf16 v[164:167], v[124:127], v[96:99], v[164:167]
  v_mfma_f32_16x16x32_bf16 v[168:171], v[108:111], v[100:103], v[168:171]
  v_mfma_f32_16x16x32_bf16 v[172:175], v[112:115], v[100:103], v[172:175]
  v_mfma_f32_16x16x32_bf16 v[176:179], v[116:119], v[100:103], v[176:179]
  v_mfma_f32_16x16x32_bf16 v[180:183], v[120:123], v[100:103], v[180:183]
  v_mfma_f32_16x16x32_bf16 v[184:187], v[124:127], v[100:103], v[184:187]
  v_mfma_f32_16x16x32_bf16 v[188:191], v[108:111], v[104:107], v[188:191]
  v_mfma_f32_16x16x32_bf16 v[192:195], v[112:115], v[104:107], v[192:195]
  v_mfma_f32_16x16x32_bf16 v[196:199], v[116:119], v[104:107], v[196:199]
  v_mfma_f32_16x16x32_bf16 v[200:203], v[120:123], v[104:107], v[200:203]
  v_mfma_f32_16x16x32_bf16 v[204:207], v[124:127], v[104:107], v[204:207]
  s_waitcnt vmcnt(5)
  v_mfma_f32_16x16x32_bf16 v[128:131], v[36:39], v[228:231], v[128:131]
  v_mfma_f32_16x16x32_bf16 v[132:135], v[40:43], v[228:231], v[132:135]
  v_mfma_f32_16x16x32_bf16 v[136:139], v[44:47], v[228:231], v[136:139]
  v_mfma_f32_16x16x32_bf16 v[140:143], v[48:51], v[228:231], v[140:143]
  v_mfma_f32_16x16x32_bf16 v[144:147], v[52:55], v[228:231], v[144:147]
  v_mfma_f32_16x16x32_bf16 v[148:151], v[36:39], v[232:235], v[148:151]
  v_mfma_f32_16x16x32_bf16 v[152:155], v[40:43], v[232:235], v[152:155]
  v_mfma_f32_16x16x32_bf16 v[156:159], v[44:47], v[232:235], v[156:159]
  v_mfma_f32_16x16x32_bf16 v[160:163], v[48:51], v[232:235], v[160:163]
  v_mfma_f32_16x16x32_bf16 v[164:167], v[52:55], v[232:235], v[164:167]
  v_mfma_f32_16x16x32_bf16 v[168:171], v[36:39], v[236:239], v[168:171]
  v_mfma_f32_16x16x32_bf16 v[172:175], v[40:43], v[236:239], v[172:175]
  v_mfma_f32_16x16x32_bf16 v[176:179], v[44:47], v[236:239], v[176:179]
  v_mfma_f32_16x16x32_bf16 v[180:183], v[48:51], v[236:239], v[180:183]
  v_mfma_f32_16x16x32_bf16 v[184:187], v[52:55], v[236:239], v[184:187]
  v_mfma_f32_16x16x32_bf16 v[188:191], v[36:39], v[240:243], v[188:191]
  v_mfma_f32_16x16x32_bf16 v[192:195], v[40:43], v[240:243], v[192:195]
  v_mfma_f32_16x16x32_bf16 v[196:199], v[44:47], v[240:243], v[196:199]
  v_mfma_f32_16x16x32_bf16 v[200:203], v[48:51], v[240:243], v[200:203]
  v_mfma_f32_16x16x32_bf16 v[204:207], v[52:55], v[240:243], v[204:207]
  s_waitcnt vmcnt(0)
  v_mfma_f32_16x16x32_bf16 v[148:151], v[72:75], v[248:251], v[148:151]
  v_mfma_f32_16x16x32_bf16 v[152:155], v[76:79], v[248:251], v[152:155]
  v_mfma_f32_16x16x32_bf16 v[156:159], v[80:83], v[248:251], v[156:159]
  v_mfma_f32_16x16x32_bf16 v[160:163], v[84:87], v[248:251], v[160:163]
  v_mfma_f32_16x16x32_bf16 v[164:167], v[88:91], v[248:251], v[164:167]
  v_mfma_f32_16x16x32_bf16 v[168:171], v[72:75], v[252:255], v[168:171]
  v_mfma_f32_16x16x32_bf16 v[172:175], v[76:79], v[252:255], v[172:175]
  v_mfma_f32_16x16x32_bf16 v[176:179], v[80:83], v[252:255], v[176:179]
  v_mfma_f32_16x16x32_bf16 v[180:183], v[84:87], v[252:255], v[180:183]
  v_mfma_f32_16x16x32_bf16 v[184:187], v[88:91], v[252:255], v[184:187]
  v_mfma_f32_16x16x32_bf16 v[188:191], v[72:75], v[4:7], v[188:191]
  ds_write_b128 v223, v[148:151] offset:0
  v_mfma_f32_16x16x32_bf16 v[192:195], v[76:79], v[4:7], v[192:195]
  ds_write_b128 v223, v[152:155] offset:1024
  v_mfma_f32_16x16x32_bf16 v[196:199], v[80:83], v[4:7], v[196:199]
  ds_write_b128 v223, v[156:159] offset:2048
  v_mfma_f32_16x16x32_bf16 v[200:203], v[84:87], v[4:7], v[200:203]
  ds_write_b128 v223, v[160:163] offset:3072
  v_mfma_f32_16x16x32_bf16 v[204:207], v[88:91], v[4:7], v[204:207]
  ds_write_b128 v223, v[164:167] offset:4096
  v_mfma_f32_16x16x32_bf16 v[128:131], v[72:75], v[244:247], v[128:131]
  ds_write_b128 v224, v[168:171] offset:0
  v_mfma_f32_16x16x32_bf16 v[132:135], v[76:79], v[244:247], v[132:135]
  ds_write_b128 v224, v[172:175] offset:1024
  v_mfma_f32_16x16x32_bf16 v[136:139], v[80:83], v[244:247], v[136:139]
  ds_write_b128 v224, v[176:179] offset:2048
  v_mfma_f32_16x16x32_bf16 v[140:143], v[84:87], v[244:247], v[140:143]
  ds_write_b128 v224, v[180:183] offset:3072
  v_mfma_f32_16x16x32_bf16 v[144:147], v[88:91], v[244:247], v[144:147]
  ds_write_b128 v224, v[184:187] offset:4096
  ds_write_b128 v225, v[188:191] offset:0
  ds_write_b128 v225, v[192:195] offset:1024
  ds_write_b128 v225, v[196:199] offset:2048
  ds_write_b128 v225, v[200:203] offset:3072
  ds_write_b128 v225, v[204:207] offset:4096
  s_mov_b32 s38, 0xffff0000
  v_mul_f32 v220, v220, v220
  v_mov_b32 v221, v220
  v_lshlrev_b32 v80, 16, v210
  v_and_b32 v81, s38, v210
  v_lshlrev_b32 v82, 16, v211
  v_and_b32 v83, s38, v211
  v_lshlrev_b32 v84, 16, v212
  v_and_b32 v85, s38, v212
  v_lshlrev_b32 v86, 16, v213
  v_and_b32 v87, s38, v213
  v_lshlrev_b32 v88, 16, v214
  v_and_b32 v89, s38, v214
  v_lshlrev_b32 v90, 16, v215
  v_and_b32 v91, s38, v215
  v_lshlrev_b32 v92, 16, v216
  v_and_b32 v93, s38, v216
  v_lshlrev_b32 v94, 16, v217
  v_and_b32 v95, s38, v217
  v_lshlrev_b32 v96, 16, v218
  v_and_b32 v97, s38, v218
  v_lshlrev_b32 v98, 16, v219
  v_and_b32 v99, s38, v219
  s_waitcnt lgkmcnt(0)
  s_barrier
  ds_read_b128 v[20:23], v222 offset:0
  ds_read_b128 v[24:27], v222 offset:1024
  ds_read_b128 v[28:31], v222 offset:2048
  ds_read_b128 v[32:35], v222 offset:3072
  ds_read_b128 v[36:39], v222 offset:4096
  ds_read_b128 v[40:43], v222 offset:5120
  ds_read_b128 v[44:47], v222 offset:6144
  ds_read_b128 v[48:51], v222 offset:7168
  ds_read_b128 v[52:55], v222 offset:8192
  ds_read_b128 v[56:59], v222 offset:9216
  ds_read_b128 v[60:63], v222 offset:10240
  ds_read_b128 v[64:67], v222 offset:11264
  ds_read_b128 v[68:71], v222 offset:12288
  ds_read_b128 v[72:75], v222 offset:13312
  ds_read_b128 v[76:79], v222 offset:14336
  s_waitcnt lgkmcnt(10)
  v_pk_add_f32 v[128:129], v[128:129], v[20:21]
  v_pk_add_f32 v[130:131], v[130:131], v[22:23]
  v_pk_add_f32 v[132:133], v[132:133], v[24:25]
  v_pk_add_f32 v[134:135], v[134:135], v[26:27]
  v_pk_add_f32 v[136:137], v[136:137], v[28:29]
  v_pk_add_f32 v[138:139], v[138:139], v[30:31]
  v_pk_add_f32 v[140:141], v[140:141], v[32:33]
  v_pk_add_f32 v[142:143], v[142:143], v[34:35]
  v_pk_add_f32 v[144:145], v[144:145], v[36:37]
  v_pk_add_f32 v[146:147], v[146:147], v[38:39]
  s_waitcnt lgkmcnt(5)
  v_pk_add_f32 v[128:129], v[128:129], v[40:41]
  v_pk_add_f32 v[130:131], v[130:131], v[42:43]
  v_pk_add_f32 v[132:133], v[132:133], v[44:45]
  v_pk_add_f32 v[134:135], v[134:135], v[46:47]
  v_pk_add_f32 v[136:137], v[136:137], v[48:49]
  v_pk_add_f32 v[138:139], v[138:139], v[50:51]
  v_pk_add_f32 v[140:141], v[140:141], v[52:53]
  v_pk_add_f32 v[142:143], v[142:143], v[54:55]
  v_pk_add_f32 v[144:145], v[144:145], v[56:57]
  v_pk_add_f32 v[146:147], v[146:147], v[58:59]
  s_waitcnt lgkmcnt(0)
  v_pk_add_f32 v[128:129], v[128:129], v[60:61]
  v_pk_add_f32 v[130:131], v[130:131], v[62:63]
  v_pk_add_f32 v[132:133], v[132:133], v[64:65]
  v_pk_add_f32 v[134:135], v[134:135], v[66:67]
  v_pk_add_f32 v[136:137], v[136:137], v[68:69]
  v_pk_add_f32 v[138:139], v[138:139], v[70:71]
  v_pk_add_f32 v[140:141], v[140:141], v[72:73]
  v_pk_add_f32 v[142:143], v[142:143], v[74:75]
  v_pk_add_f32 v[144:145], v[144:145], v[76:77]
  v_pk_add_f32 v[146:147], v[146:147], v[78:79]
  v_pk_fma_f32 v[128:129], v[128:129], v[220:221], v[80:81]
  v_pk_fma_f32 v[130:131], v[130:131], v[220:221], v[82:83]
  v_pk_fma_f32 v[132:133], v[132:133], v[220:221], v[84:85]
  v_pk_fma_f32 v[134:135], v[134:135], v[220:221], v[86:87]
  v_pk_fma_f32 v[136:137], v[136:137], v[220:221], v[88:89]
  v_pk_fma_f32 v[138:139], v[138:139], v[220:221], v[90:91]
  v_pk_fma_f32 v[140:141], v[140:141], v[220:221], v[92:93]
  v_pk_fma_f32 v[142:143], v[142:143], v[220:221], v[94:95]
  v_pk_fma_f32 v[144:145], v[144:145], v[220:221], v[96:97]
  v_pk_fma_f32 v[146:147], v[146:147], v[220:221], v[98:99]
  v_cvt_pk_bf16_f32 v210, v128, v129
  v_cvt_pk_bf16_f32 v211, v130, v131
  v_cvt_pk_bf16_f32 v212, v132, v133
  v_cvt_pk_bf16_f32 v213, v134, v135
  v_cvt_pk_bf16_f32 v214, v136, v137
  v_cvt_pk_bf16_f32 v215, v138, v139
  v_cvt_pk_bf16_f32 v216, v140, v141
  v_cvt_pk_bf16_f32 v217, v142, v143
  v_cvt_pk_bf16_f32 v218, v144, v145
  v_cvt_pk_bf16_f32 v219, v146, v147
  buffer_store_dwordx4 v[210:213], v208, s[8:11], 0 offen
  buffer_store_dwordx4 v[214:217], v208, s[8:11], 0 offen offset:16
  buffer_store_dwordx2 v[218:219], v208, s[8:11], 0 offen offset:32
L2_out:
L2_end:
  s_endpgm
.section .rodata,"a"
.p2align 6
.amdhsa_kernel parallel_sum__mha_block__glu_gated_bilinear__prompt_kernel
  .amdhsa_next_free_vgpr 256
  .amdhsa_next_free_sgpr 98
  .amdhsa_accum_offset 256
  .amdhsa_group_segment_fixed_size 0
  .amdhsa_kernarg_size 80
  .amdhsa_user_sgpr_count 2
  .amdhsa_user_sgpr_kernarg_segment_ptr 1
  .amdhsa_system_sgpr_workgroup_id_x 1
.end_amdhsa_kernel
```
